```python
import torch

def _softmax(x, axis=-1):
    return torch.softmax(x, dim=axis)

def _gelu(x):
    return torch.nn.functional.gelu(x, approximate='tanh')

def _silu(x):
    return torch.nn.functional.silu(x)

def _sigmoid(x):
    return torch.sigmoid(x)

def _layernorm(x, axis=-1, eps=1e-05):
    m = x.mean(dim=axis, keepdim=True)
    v = x.var(dim=axis, keepdim=True, unbiased=False)
    return (x - m) / torch.sqrt(v + eps)

def _scatter_add(tgt, idx, src, axis=0):
    return tgt.clone().index_add_(axis, idx, src)

def _segment_sum(src, seg, n):
    out = torch.zeros((n,) + src.shape[1:], dtype=src.dtype)
    return out.index_add_(0, seg, src)

def _pad(x, pw):
    flat = tuple((v for pair in reversed(pw) for v in pair))
    return torch.nn.functional.pad(x, flat)
kernel_name = 'adaLN_cond__ssm_conv_s4d__mixer_channel_mlp__prompt'

def setup_inputs():

    _w = lambda a: (lambda t: t.to(torch.bfloat16) if t.is_floating_point() else t)(torch.as_tensor(a))

    def _A_setup():
        Bsz, L, D, N = (1, 2048, 576, 128)
        return {'u': _w((lambda *s: torch.randn(*s, dtype=torch.bfloat16) * 0.05)(Bsz, L, D)), 'log_A_real': _w((lambda *s: torch.randn(*s, dtype=torch.bfloat16) * 3.2)(D, N) * 0.5), 'A_imag': _w((lambda *s: torch.randn(*s, dtype=torch.bfloat16) * 0.05)(D, N) * 3.14), 'C_real': _w((lambda *s: torch.randn(*s, dtype=torch.bfloat16) * 0.2)(D, N) / N ** 0.5), 'C_imag': _w((lambda *s: torch.randn(*s, dtype=torch.bfloat16) * 0.2)(D, N) / N ** 0.5), 'log_dt': _w((lambda *s: torch.randn(*s, dtype=torch.bfloat16) * 0.05)(D) * 0.5 - 4.0), 'D_skip': _w((lambda *s: torch.randn(*s, dtype=torch.bfloat16) * 0.05)(D))}
    _A_in = _A_setup()

    def _B_setup():
        B, S, D, F = (1, 2048, 576, 4608)
        return {'x': _w((lambda *s: torch.randn(*s, dtype=torch.bfloat16) * 0.05)(B, S, D)), 'w1': _w((lambda *s: torch.randn(*s, dtype=torch.bfloat16) * 3.2)(D, F) * D ** (-0.5)), 'b1': _w((lambda *s: torch.randn(*s, dtype=torch.bfloat16) * 1.6)(F)), 'w2': _w((lambda *s: torch.randn(*s, dtype=torch.bfloat16) * 1.6)(F, D) * F ** (-0.5)), 'b2': _w((lambda *s: torch.randn(*s, dtype=torch.bfloat16) * 1.6)(D))}
    _B_in = _B_setup()
    return {'A_u': _A_in['u'], 'A_log_A_real': _A_in['log_A_real'], 'A_A_imag': _A_in['A_imag'], 'A_C_real': _A_in['C_real'], 'A_C_imag': _A_in['C_imag'], 'A_log_dt': _A_in['log_dt'], 'A_D_skip': _A_in['D_skip'], 'B_x': _B_in['x'], 'B_w1': _B_in['w1'], 'B_b1': _B_in['b1'], 'B_w2': _B_in['w2'], 'B_b2': _B_in['b2'], 'c': _w((lambda *s: torch.randn(*s, dtype=torch.bfloat16) * 0.2)(1, 576) * 8.0), 'w_mod': _w((lambda *s: torch.randn(*s, dtype=torch.bfloat16) * 0.2)(576, 6 * 576) * 576 ** (-0.5) * 8.0)}

def reference(A_u, A_log_A_real, A_A_imag, A_C_real, A_C_imag, A_log_dt, A_D_skip, B_x, B_w1, B_b1, B_w2, B_b2, c, w_mod):

    def _A_ref(u, log_A_real, A_imag, C_real, C_imag, log_dt, D_skip):
        L = u.shape[1]
        dt = torch.exp(log_dt)
        A = -torch.exp(log_A_real) + 1j * A_imag
        C = (C_real + 1j * C_imag) * dt[:, None]
        pos = (lambda x, dt: x.to(dt))(torch.arange(L), log_dt.dtype)
        P = torch.exp((A * dt[:, None])[:, :, None] * pos[None, None, :])
        K = 2.0 * torch.einsum('dn,dnl->dl', C, P).real
        L2 = 2 * L
        u_t = (lambda x, *d: x.permute(*d))(u, 0, 2, 1)
        Kf = (lambda x, *a, **k: torch.fft.rfft(x.float(), *a, **k))(K, L2)
        Uf = (lambda x, *a, **k: torch.fft.rfft(x.float(), *a, **k))(u_t, L2)
        y = (lambda x, *a, **k: torch.fft.irfft(x, *a, **k).to(torch.bfloat16))(Uf * Kf[None, :, :], L2)[:, :, :L]
        y = (lambda x, *d: x.permute(*d))(y, 0, 2, 1)
        return y + u * D_skip[None, None, :]

    def _B_ref(x, w1, b1, w2, b2):
        y = _layernorm(x, axis=-1)
        h = _gelu(torch.einsum('bsd,df->bsf', y, w1) + b1)
        return torch.einsum('bsf,fd->bsd', h, w2) + b2
    x = A_u
    mod = (_silu(c) @ w_mod).reshape(c.shape[0], 6, 1, -1)
    sa, ca, ga, sb, cb, gb = (mod[:, 0].clone(), mod[:, 1].clone(), mod[:, 2].clone(), mod[:, 3].clone(), mod[:, 4].clone(), mod[:, 5].clone())
    h = _layernorm(x, axis=-1) * (1 + ca) + sa
    x = x + ga * _A_ref(h, A_log_A_real, A_A_imag, A_C_real, A_C_imag, A_log_dt, A_D_skip)
    h = _layernorm(x, axis=-1) * (1 + cb) + sb
    x = x + gb * _B_ref(h, B_w1, B_b1, B_w2, B_b2)
    return x
```

```asm
; @launch kernel=prep_kernel grid=(947,1,1) block=(256,1,1) lds=38272
; @launch kernel=conv_kernel grid=(256,1,1) block=(768,1,1) lds=124416
; @launch kernel=mlp_kernel grid=(256,1,1) block=(512,1,1) lds=156672
.amdgcn_target "amdgcn-amd-amdhsa--gfx950"
.text
.globl prep_kernel
.p2align 8
.type prep_kernel,@function
prep_kernel:
    s_cmp_ge_u32 s2, 947
    s_cbranch_scc1 L_prep_end
    s_cmp_lt_u32 s2, 8
    s_cbranch_scc0 L_nocpf
    s_getpc_b64 s[40:41]
L_pc:
    s_sub_u32 s40, s40, L_pc - prep_kernel
    s_subb_u32 s41, s41, 0
    v_lshlrev_b32 v124, 7, v0
    v_cmp_gt_u32 vcc, L_mlp_end - prep_kernel, v124
    v_mov_b32 v127, s41
    v_add_co_u32 v126, s[44:45], s40, v124
    s_nop 1
    v_addc_co_u32 v127, s[44:45], 0, v127, s[44:45]
    s_and_saveexec_b64 s[42:43], vcc
    global_load_dword v125, v[126:127], off
    s_mov_b64 exec, s[42:43]
    s_getpc_b64 s[40:41]
    s_add_u32 s40, s40, L_kd_conv_kernel@rel32@lo+4
    s_addc_u32 s41, s41, L_kd_conv_kernel@rel32@hi+12
    v_mov_b32 v120, s40
    v_mov_b32 v121, s41
    global_load_dword v125, v[120:121], off
    s_getpc_b64 s[40:41]
    s_add_u32 s40, s40, L_kd_mlp_kernel@rel32@lo+4
    s_addc_u32 s41, s41, L_kd_mlp_kernel@rel32@hi+12
    v_mov_b32 v122, s40
    v_mov_b32 v123, s41
    global_load_dword v125, v[122:123], off
L_nocpf:
    s_load_dwordx2 s[26:27], s[0:1], 128
    v_and_b32 v1, 63, v0
    v_lshrrev_b32 v2, 6, v0
    s_nop 0
    v_readfirstlane_b32 s33, v2
    s_lshr_b32 s34, s2, 3
    s_and_b32 s35, s2, 7
    s_mov_b32 s38, 0
    s_cmp_lt_u32 s34, 8
    s_cbranch_scc1 L_ln
    s_cmp_lt_u32 s34, 16
    s_cbranch_scc0 L_notr
    s_sub_u32 s2, s2, 64
    s_mov_b32 s38, 1
    s_branch L_ln
L_notr:
    s_sub_u32 s36, s34, 16
    s_cmp_lt_u32 s34, 64
    s_cbranch_scc1 L_kmap
    s_sub_u32 s36, s34, 24
    s_sub_u32 s37, s34, 72
    s_cmp_lt_u32 s37, 24
    s_cbranch_scc1 L_kmap
    s_sub_u32 s36, s34, 64
    s_sub_u32 s37, s34, 88
    s_cmp_lt_u32 s34, 72
    s_cselect_b32 s36, s36, s37
    s_lshl_b32 s36, s36, 3
    s_add_u32 s36, s36, s35
    s_add_u32 s2, s36, 640
    s_branch L_mod
L_kmap:
    s_lshl_b32 s36, s36, 3
    s_add_u32 s36, s36, s35
    s_add_u32 s2, s36, 64
    s_branch L_kgen
L_ln:
    s_load_dwordx2 s[20:21], s[0:1], 0
    s_setprio 3
    v_lshrrev_b32 v3, 3, v0
    v_and_b32 v4, 7, v0
    s_lshl_b32 s34, s2, 5
    v_add_u32 v5, s34, v3
    v_mul_u32_u24 v5, 1152, v5
    v_lshlrev_b32 v6, 4, v4
    v_add_u32 v5, v5, v6
    s_waitcnt lgkmcnt(0)
    s_mov_b32 s4, s26
    s_mov_b32 s5, s27
    s_mov_b32 s6, 268435456
    s_mov_b32 s7, 0x20000
    s_mov_b32 s8, s20
    s_mov_b32 s9, s21
    s_mov_b32 s10, 2359296
    s_mov_b32 s11, 0x20000
    buffer_load_dwordx4 v[16:19], v5, s[8:11], 0 offen offset:0
    buffer_load_dwordx4 v[20:23], v5, s[8:11], 0 offen offset:128
    buffer_load_dwordx4 v[24:27], v5, s[8:11], 0 offen offset:256
    buffer_load_dwordx4 v[28:31], v5, s[8:11], 0 offen offset:384
    buffer_load_dwordx4 v[32:35], v5, s[8:11], 0 offen offset:512
    buffer_load_dwordx4 v[36:39], v5, s[8:11], 0 offen offset:640
    buffer_load_dwordx4 v[40:43], v5, s[8:11], 0 offen offset:768
    buffer_load_dwordx4 v[44:47], v5, s[8:11], 0 offen offset:896
    buffer_load_dwordx4 v[48:51], v5, s[8:11], 0 offen offset:1024
    v_mul_u32_u24 v7, 1184, v3
    v_lshrrev_b32 v8, 3, v3
    v_lshlrev_b32 v8, 7, v8
    v_add_u32 v7, v7, v8
    v_add_u32 v7, v7, v6
    v_lshrrev_b32 v3, 4, v1
    v_and_b32 v4, 15, v1
    v_lshrrev_b32 v5, 2, v4
    v_and_b32 v6, 3, v1
    v_lshlrev_b32 v14, 3, v3
    v_add_u32 v14, v14, v5
    v_mul_u32_u24 v14, 1184, v14
    v_lshlrev_b32 v8, 7, v3
    v_add_u32 v14, v14, v8
    v_lshlrev_b32 v8, 3, v6
    v_add_u32 v14, v14, v8
    s_mul_i32 s35, s33, 288
    v_add_u32 v14, s35, v14
    s_mul_i32 s35, s33, 144
    v_add_u32 v8, s35, v4
    v_lshlrev_b32 v8, 6, v8
    v_lshlrev_b32 v9, 4, v3
    v_add_u32 v8, v8, v9
    s_mul_i32 s35, s2, 36864
    v_add_u32 v8, s35, v8
    s_cmp_eq_u32 s38, 0
    s_cbranch_scc1 L_ln_norm
    s_waitcnt vmcnt(8)
    ds_write_b128 v7, v[16:19] offset:0
    s_waitcnt vmcnt(7)
    ds_write_b128 v7, v[20:23] offset:128
    s_waitcnt vmcnt(6)
    ds_write_b128 v7, v[24:27] offset:256
    s_waitcnt vmcnt(5)
    ds_write_b128 v7, v[28:31] offset:384
    s_waitcnt vmcnt(4)
    ds_write_b128 v7, v[32:35] offset:512
    s_waitcnt vmcnt(3)
    ds_write_b128 v7, v[36:39] offset:640
    s_waitcnt vmcnt(2)
    ds_write_b128 v7, v[40:43] offset:768
    s_waitcnt vmcnt(1)
    ds_write_b128 v7, v[44:47] offset:896
    s_waitcnt vmcnt(0)
    ds_write_b128 v7, v[48:51] offset:1024
    s_waitcnt lgkmcnt(0)
    s_barrier
    ds_read_b64_tr_b16 v[52:53], v14 offset:0
    ds_read_b64_tr_b16 v[54:55], v14 offset:4736
    ds_read_b64_tr_b16 v[56:57], v14 offset:32
    ds_read_b64_tr_b16 v[58:59], v14 offset:4768
    ds_read_b64_tr_b16 v[60:61], v14 offset:64
    ds_read_b64_tr_b16 v[62:63], v14 offset:4800
    ds_read_b64_tr_b16 v[64:65], v14 offset:96
    ds_read_b64_tr_b16 v[66:67], v14 offset:4832
    ds_read_b64_tr_b16 v[68:69], v14 offset:128
    ds_read_b64_tr_b16 v[70:71], v14 offset:4864
    ds_read_b64_tr_b16 v[72:73], v14 offset:160
    ds_read_b64_tr_b16 v[74:75], v14 offset:4896
    ds_read_b64_tr_b16 v[76:77], v14 offset:192
    ds_read_b64_tr_b16 v[78:79], v14 offset:4928
    ds_read_b64_tr_b16 v[80:81], v14 offset:224
    ds_read_b64_tr_b16 v[82:83], v14 offset:4960
    ds_read_b64_tr_b16 v[84:85], v14 offset:256
    ds_read_b64_tr_b16 v[86:87], v14 offset:4992
    s_waitcnt lgkmcnt(15)
    s_mov_b32 s36, 0
    buffer_store_dwordx4 v[52:55], v8, s[4:7], s36 offen
    s_waitcnt lgkmcnt(14)
    s_mov_b32 s36, 1024
    buffer_store_dwordx4 v[56:59], v8, s[4:7], s36 offen
    s_waitcnt lgkmcnt(12)
    s_mov_b32 s36, 2048
    buffer_store_dwordx4 v[60:63], v8, s[4:7], s36 offen
    s_waitcnt lgkmcnt(10)
    s_mov_b32 s36, 3072
    buffer_store_dwordx4 v[64:67], v8, s[4:7], s36 offen
    s_waitcnt lgkmcnt(8)
    s_mov_b32 s36, 4096
    buffer_store_dwordx4 v[68:71], v8, s[4:7], s36 offen
    s_waitcnt lgkmcnt(6)
    s_mov_b32 s36, 5120
    buffer_store_dwordx4 v[72:75], v8, s[4:7], s36 offen
    s_waitcnt lgkmcnt(4)
    s_mov_b32 s36, 6144
    buffer_store_dwordx4 v[76:79], v8, s[4:7], s36 offen
    s_waitcnt lgkmcnt(2)
    s_mov_b32 s36, 7168
    buffer_store_dwordx4 v[80:83], v8, s[4:7], s36 offen
    s_waitcnt lgkmcnt(0)
    s_mov_b32 s36, 8192
    buffer_store_dwordx4 v[84:87], v8, s[4:7], s36 offen
    s_branch L_prep_fin
L_ln_norm:
    v_mov_b32 v10, 0
    v_mov_b32 v11, 0
    s_waitcnt vmcnt(8)
    v_lshlrev_b32 v52, 16, v16
    v_and_b32 v53, 0xffff0000, v16
    v_lshlrev_b32 v54, 16, v17
    v_and_b32 v55, 0xffff0000, v17
    v_lshlrev_b32 v56, 16, v18
    v_and_b32 v57, 0xffff0000, v18
    v_lshlrev_b32 v58, 16, v19
    v_and_b32 v59, 0xffff0000, v19
    v_pk_add_f32 v[10:11], v[10:11], v[52:53]
    v_pk_add_f32 v[10:11], v[10:11], v[54:55]
    v_pk_add_f32 v[10:11], v[10:11], v[56:57]
    v_pk_add_f32 v[10:11], v[10:11], v[58:59]
    s_waitcnt vmcnt(7)
    v_lshlrev_b32 v60, 16, v20
    v_and_b32 v61, 0xffff0000, v20
    v_lshlrev_b32 v62, 16, v21
    v_and_b32 v63, 0xffff0000, v21
    v_lshlrev_b32 v64, 16, v22
    v_and_b32 v65, 0xffff0000, v22
    v_lshlrev_b32 v66, 16, v23
    v_and_b32 v67, 0xffff0000, v23
    v_pk_add_f32 v[10:11], v[10:11], v[60:61]
    v_pk_add_f32 v[10:11], v[10:11], v[62:63]
    v_pk_add_f32 v[10:11], v[10:11], v[64:65]
    v_pk_add_f32 v[10:11], v[10:11], v[66:67]
    s_waitcnt vmcnt(6)
    v_lshlrev_b32 v68, 16, v24
    v_and_b32 v69, 0xffff0000, v24
    v_lshlrev_b32 v70, 16, v25
    v_and_b32 v71, 0xffff0000, v25
    v_lshlrev_b32 v72, 16, v26
    v_and_b32 v73, 0xffff0000, v26
    v_lshlrev_b32 v74, 16, v27
    v_and_b32 v75, 0xffff0000, v27
    v_pk_add_f32 v[10:11], v[10:11], v[68:69]
    v_pk_add_f32 v[10:11], v[10:11], v[70:71]
    v_pk_add_f32 v[10:11], v[10:11], v[72:73]
    v_pk_add_f32 v[10:11], v[10:11], v[74:75]
    s_waitcnt vmcnt(5)
    v_lshlrev_b32 v76, 16, v28
    v_and_b32 v77, 0xffff0000, v28
    v_lshlrev_b32 v78, 16, v29
    v_and_b32 v79, 0xffff0000, v29
    v_lshlrev_b32 v80, 16, v30
    v_and_b32 v81, 0xffff0000, v30
    v_lshlrev_b32 v82, 16, v31
    v_and_b32 v83, 0xffff0000, v31
    v_pk_add_f32 v[10:11], v[10:11], v[76:77]
    v_pk_add_f32 v[10:11], v[10:11], v[78:79]
    v_pk_add_f32 v[10:11], v[10:11], v[80:81]
    v_pk_add_f32 v[10:11], v[10:11], v[82:83]
    s_waitcnt vmcnt(4)
    v_lshlrev_b32 v84, 16, v32
    v_and_b32 v85, 0xffff0000, v32
    v_lshlrev_b32 v86, 16, v33
    v_and_b32 v87, 0xffff0000, v33
    v_lshlrev_b32 v88, 16, v34
    v_and_b32 v89, 0xffff0000, v34
    v_lshlrev_b32 v90, 16, v35
    v_and_b32 v91, 0xffff0000, v35
    v_pk_add_f32 v[10:11], v[10:11], v[84:85]
    v_pk_add_f32 v[10:11], v[10:11], v[86:87]
    v_pk_add_f32 v[10:11], v[10:11], v[88:89]
    v_pk_add_f32 v[10:11], v[10:11], v[90:91]
    s_waitcnt vmcnt(3)
    v_lshlrev_b32 v92, 16, v36
    v_and_b32 v93, 0xffff0000, v36
    v_lshlrev_b32 v94, 16, v37
    v_and_b32 v95, 0xffff0000, v37
    v_lshlrev_b32 v96, 16, v38
    v_and_b32 v97, 0xffff0000, v38
    v_lshlrev_b32 v98, 16, v39
    v_and_b32 v99, 0xffff0000, v39
    v_pk_add_f32 v[10:11], v[10:11], v[92:93]
    v_pk_add_f32 v[10:11], v[10:11], v[94:95]
    v_pk_add_f32 v[10:11], v[10:11], v[96:97]
    v_pk_add_f32 v[10:11], v[10:11], v[98:99]
    s_waitcnt vmcnt(2)
    v_lshlrev_b32 v100, 16, v40
    v_and_b32 v101, 0xffff0000, v40
    v_lshlrev_b32 v102, 16, v41
    v_and_b32 v103, 0xffff0000, v41
    v_lshlrev_b32 v104, 16, v42
    v_and_b32 v105, 0xffff0000, v42
    v_lshlrev_b32 v106, 16, v43
    v_and_b32 v107, 0xffff0000, v43
    v_pk_add_f32 v[10:11], v[10:11], v[100:101]
    v_pk_add_f32 v[10:11], v[10:11], v[102:103]
    v_pk_add_f32 v[10:11], v[10:11], v[104:105]
    v_pk_add_f32 v[10:11], v[10:11], v[106:107]
    s_waitcnt vmcnt(1)
    v_lshlrev_b32 v108, 16, v44
    v_and_b32 v109, 0xffff0000, v44
    v_lshlrev_b32 v110, 16, v45
    v_and_b32 v111, 0xffff0000, v45
    v_lshlrev_b32 v112, 16, v46
    v_and_b32 v113, 0xffff0000, v46
    v_lshlrev_b32 v114, 16, v47
    v_and_b32 v115, 0xffff0000, v47
    v_pk_add_f32 v[10:11], v[10:11], v[108:109]
    v_pk_add_f32 v[10:11], v[10:11], v[110:111]
    v_pk_add_f32 v[10:11], v[10:11], v[112:113]
    v_pk_add_f32 v[10:11], v[10:11], v[114:115]
    s_waitcnt vmcnt(0)
    v_lshlrev_b32 v116, 16, v48
    v_and_b32 v117, 0xffff0000, v48
    v_lshlrev_b32 v118, 16, v49
    v_and_b32 v119, 0xffff0000, v49
    v_lshlrev_b32 v120, 16, v50
    v_and_b32 v121, 0xffff0000, v50
    v_lshlrev_b32 v122, 16, v51
    v_and_b32 v123, 0xffff0000, v51
    v_pk_add_f32 v[10:11], v[10:11], v[116:117]
    v_pk_add_f32 v[10:11], v[10:11], v[118:119]
    v_pk_add_f32 v[10:11], v[10:11], v[120:121]
    v_pk_add_f32 v[10:11], v[10:11], v[122:123]
    v_add_f32 v10, v10, v11
    s_nop 1
    v_add_f32_dpp v10, v10, v10 quad_perm:[1,0,3,2] row_mask:0xf bank_mask:0xf
    s_nop 1
    v_add_f32_dpp v10, v10, v10 quad_perm:[2,3,0,1] row_mask:0xf bank_mask:0xf
    s_nop 1
    v_add_f32_dpp v10, v10, v10 row_half_mirror row_mask:0xf bank_mask:0xf
    v_mul_f32 v10, 0xbae38e39, v10
    v_mov_b32 v12, 0
    v_mov_b32 v11, v10
    v_mov_b32 v13, 0
    v_pk_add_f32 v[52:53], v[52:53], v[10:11]
    v_pk_add_f32 v[54:55], v[54:55], v[10:11]
    v_pk_add_f32 v[56:57], v[56:57], v[10:11]
    v_pk_add_f32 v[58:59], v[58:59], v[10:11]
    v_pk_add_f32 v[60:61], v[60:61], v[10:11]
    v_pk_add_f32 v[62:63], v[62:63], v[10:11]
    v_pk_add_f32 v[64:65], v[64:65], v[10:11]
    v_pk_add_f32 v[66:67], v[66:67], v[10:11]
    v_pk_add_f32 v[68:69], v[68:69], v[10:11]
    v_pk_add_f32 v[70:71], v[70:71], v[10:11]
    v_pk_add_f32 v[72:73], v[72:73], v[10:11]
    v_pk_add_f32 v[74:75], v[74:75], v[10:11]
    v_pk_add_f32 v[76:77], v[76:77], v[10:11]
    v_pk_add_f32 v[78:79], v[78:79], v[10:11]
    v_pk_add_f32 v[80:81], v[80:81], v[10:11]
    v_pk_add_f32 v[82:83], v[82:83], v[10:11]
    v_pk_add_f32 v[84:85], v[84:85], v[10:11]
    v_pk_add_f32 v[86:87], v[86:87], v[10:11]
    v_pk_add_f32 v[88:89], v[88:89], v[10:11]
    v_pk_add_f32 v[90:91], v[90:91], v[10:11]
    v_pk_add_f32 v[92:93], v[92:93], v[10:11]
    v_pk_add_f32 v[94:95], v[94:95], v[10:11]
    v_pk_add_f32 v[96:97], v[96:97], v[10:11]
    v_pk_add_f32 v[98:99], v[98:99], v[10:11]
    v_pk_add_f32 v[100:101], v[100:101], v[10:11]
    v_pk_add_f32 v[102:103], v[102:103], v[10:11]
    v_pk_add_f32 v[104:105], v[104:105], v[10:11]
    v_pk_add_f32 v[106:107], v[106:107], v[10:11]
    v_pk_add_f32 v[108:109], v[108:109], v[10:11]
    v_pk_add_f32 v[110:111], v[110:111], v[10:11]
    v_pk_add_f32 v[112:113], v[112:113], v[10:11]
    v_pk_add_f32 v[114:115], v[114:115], v[10:11]
    v_pk_add_f32 v[116:117], v[116:117], v[10:11]
    v_pk_add_f32 v[118:119], v[118:119], v[10:11]
    v_pk_add_f32 v[120:121], v[120:121], v[10:11]
    v_pk_add_f32 v[122:123], v[122:123], v[10:11]
    v_pk_fma_f32 v[12:13], v[52:53], v[52:53], v[12:13]
    v_pk_fma_f32 v[12:13], v[54:55], v[54:55], v[12:13]
    v_pk_fma_f32 v[12:13], v[56:57], v[56:57], v[12:13]
    v_pk_fma_f32 v[12:13], v[58:59], v[58:59], v[12:13]
    v_pk_fma_f32 v[12:13], v[60:61], v[60:61], v[12:13]
    v_pk_fma_f32 v[12:13], v[62:63], v[62:63], v[12:13]
    v_pk_fma_f32 v[12:13], v[64:65], v[64:65], v[12:13]
    v_pk_fma_f32 v[12:13], v[66:67], v[66:67], v[12:13]
    v_pk_fma_f32 v[12:13], v[68:69], v[68:69], v[12:13]
    v_pk_fma_f32 v[12:13], v[70:71], v[70:71], v[12:13]
    v_pk_fma_f32 v[12:13], v[72:73], v[72:73], v[12:13]
    v_pk_fma_f32 v[12:13], v[74:75], v[74:75], v[12:13]
    v_pk_fma_f32 v[12:13], v[76:77], v[76:77], v[12:13]
    v_pk_fma_f32 v[12:13], v[78:79], v[78:79], v[12:13]
    v_pk_fma_f32 v[12:13], v[80:81], v[80:81], v[12:13]
    v_pk_fma_f32 v[12:13], v[82:83], v[82:83], v[12:13]
    v_pk_fma_f32 v[12:13], v[84:85], v[84:85], v[12:13]
    v_pk_fma_f32 v[12:13], v[86:87], v[86:87], v[12:13]
    v_pk_fma_f32 v[12:13], v[88:89], v[88:89], v[12:13]
    v_pk_fma_f32 v[12:13], v[90:91], v[90:91], v[12:13]
    v_pk_fma_f32 v[12:13], v[92:93], v[92:93], v[12:13]
    v_pk_fma_f32 v[12:13], v[94:95], v[94:95], v[12:13]
    v_pk_fma_f32 v[12:13], v[96:97], v[96:97], v[12:13]
    v_pk_fma_f32 v[12:13], v[98:99], v[98:99], v[12:13]
    v_pk_fma_f32 v[12:13], v[100:101], v[100:101], v[12:13]
    v_pk_fma_f32 v[12:13], v[102:103], v[102:103], v[12:13]
    v_pk_fma_f32 v[12:13], v[104:105], v[104:105], v[12:13]
    v_pk_fma_f32 v[12:13], v[106:107], v[106:107], v[12:13]
    v_pk_fma_f32 v[12:13], v[108:109], v[108:109], v[12:13]
    v_pk_fma_f32 v[12:13], v[110:111], v[110:111], v[12:13]
    v_pk_fma_f32 v[12:13], v[112:113], v[112:113], v[12:13]
    v_pk_fma_f32 v[12:13], v[114:115], v[114:115], v[12:13]
    v_pk_fma_f32 v[12:13], v[116:117], v[116:117], v[12:13]
    v_pk_fma_f32 v[12:13], v[118:119], v[118:119], v[12:13]
    v_pk_fma_f32 v[12:13], v[120:121], v[120:121], v[12:13]
    v_pk_fma_f32 v[12:13], v[122:123], v[122:123], v[12:13]
    v_add_f32 v12, v12, v13
    s_nop 1
    v_add_f32_dpp v12, v12, v12 quad_perm:[1,0,3,2] row_mask:0xf bank_mask:0xf
    s_nop 1
    v_add_f32_dpp v12, v12, v12 quad_perm:[2,3,0,1] row_mask:0xf bank_mask:0xf
    s_nop 1
    v_add_f32_dpp v12, v12, v12 row_half_mirror row_mask:0xf bank_mask:0xf
    v_mul_f32 v12, 0x3ae38e39, v12
    v_add_f32 v12, 0x3727c5ac, v12
    v_rsq_f32 v12, v12
    s_nop 0
    v_mov_b32 v13, v12
    v_pk_mul_f32 v[52:53], v[52:53], v[12:13]
    v_cvt_pk_bf16_f32 v16, v52, v53
    v_pk_mul_f32 v[54:55], v[54:55], v[12:13]
    v_cvt_pk_bf16_f32 v17, v54, v55
    v_pk_mul_f32 v[56:57], v[56:57], v[12:13]
    v_cvt_pk_bf16_f32 v18, v56, v57
    v_pk_mul_f32 v[58:59], v[58:59], v[12:13]
    v_cvt_pk_bf16_f32 v19, v58, v59
    v_pk_mul_f32 v[60:61], v[60:61], v[12:13]
    v_cvt_pk_bf16_f32 v20, v60, v61
    v_pk_mul_f32 v[62:63], v[62:63], v[12:13]
    v_cvt_pk_bf16_f32 v21, v62, v63
    v_pk_mul_f32 v[64:65], v[64:65], v[12:13]
    v_cvt_pk_bf16_f32 v22, v64, v65
    v_pk_mul_f32 v[66:67], v[66:67], v[12:13]
    v_cvt_pk_bf16_f32 v23, v66, v67
    v_pk_mul_f32 v[68:69], v[68:69], v[12:13]
    v_cvt_pk_bf16_f32 v24, v68, v69
    v_pk_mul_f32 v[70:71], v[70:71], v[12:13]
    v_cvt_pk_bf16_f32 v25, v70, v71
    v_pk_mul_f32 v[72:73], v[72:73], v[12:13]
    v_cvt_pk_bf16_f32 v26, v72, v73
    v_pk_mul_f32 v[74:75], v[74:75], v[12:13]
    v_cvt_pk_bf16_f32 v27, v74, v75
    v_pk_mul_f32 v[76:77], v[76:77], v[12:13]
    v_cvt_pk_bf16_f32 v28, v76, v77
    v_pk_mul_f32 v[78:79], v[78:79], v[12:13]
    v_cvt_pk_bf16_f32 v29, v78, v79
    v_pk_mul_f32 v[80:81], v[80:81], v[12:13]
    v_cvt_pk_bf16_f32 v30, v80, v81
    v_pk_mul_f32 v[82:83], v[82:83], v[12:13]
    v_cvt_pk_bf16_f32 v31, v82, v83
    v_pk_mul_f32 v[84:85], v[84:85], v[12:13]
    v_cvt_pk_bf16_f32 v32, v84, v85
    v_pk_mul_f32 v[86:87], v[86:87], v[12:13]
    v_cvt_pk_bf16_f32 v33, v86, v87
    v_pk_mul_f32 v[88:89], v[88:89], v[12:13]
    v_cvt_pk_bf16_f32 v34, v88, v89
    v_pk_mul_f32 v[90:91], v[90:91], v[12:13]
    v_cvt_pk_bf16_f32 v35, v90, v91
    v_pk_mul_f32 v[92:93], v[92:93], v[12:13]
    v_cvt_pk_bf16_f32 v36, v92, v93
    v_pk_mul_f32 v[94:95], v[94:95], v[12:13]
    v_cvt_pk_bf16_f32 v37, v94, v95
    v_pk_mul_f32 v[96:97], v[96:97], v[12:13]
    v_cvt_pk_bf16_f32 v38, v96, v97
    v_pk_mul_f32 v[98:99], v[98:99], v[12:13]
    v_cvt_pk_bf16_f32 v39, v98, v99
    v_pk_mul_f32 v[100:101], v[100:101], v[12:13]
    v_cvt_pk_bf16_f32 v40, v100, v101
    v_pk_mul_f32 v[102:103], v[102:103], v[12:13]
    v_cvt_pk_bf16_f32 v41, v102, v103
    v_pk_mul_f32 v[104:105], v[104:105], v[12:13]
    v_cvt_pk_bf16_f32 v42, v104, v105
    v_pk_mul_f32 v[106:107], v[106:107], v[12:13]
    v_cvt_pk_bf16_f32 v43, v106, v107
    v_pk_mul_f32 v[108:109], v[108:109], v[12:13]
    v_cvt_pk_bf16_f32 v44, v108, v109
    v_pk_mul_f32 v[110:111], v[110:111], v[12:13]
    v_cvt_pk_bf16_f32 v45, v110, v111
    v_pk_mul_f32 v[112:113], v[112:113], v[12:13]
    v_cvt_pk_bf16_f32 v46, v112, v113
    v_pk_mul_f32 v[114:115], v[114:115], v[12:13]
    v_cvt_pk_bf16_f32 v47, v114, v115
    v_pk_mul_f32 v[116:117], v[116:117], v[12:13]
    v_cvt_pk_bf16_f32 v48, v116, v117
    v_pk_mul_f32 v[118:119], v[118:119], v[12:13]
    v_cvt_pk_bf16_f32 v49, v118, v119
    v_pk_mul_f32 v[120:121], v[120:121], v[12:13]
    v_cvt_pk_bf16_f32 v50, v120, v121
    v_pk_mul_f32 v[122:123], v[122:123], v[12:13]
    v_cvt_pk_bf16_f32 v51, v122, v123
    ds_write_b128 v7, v[16:19] offset:0
    ds_write_b128 v7, v[20:23] offset:128
    ds_write_b128 v7, v[24:27] offset:256
    ds_write_b128 v7, v[28:31] offset:384
    ds_write_b128 v7, v[32:35] offset:512
    ds_write_b128 v7, v[36:39] offset:640
    ds_write_b128 v7, v[40:43] offset:768
    ds_write_b128 v7, v[44:47] offset:896
    ds_write_b128 v7, v[48:51] offset:1024
    s_waitcnt lgkmcnt(0)
    s_barrier
    ds_read_b64_tr_b16 v[52:53], v14 offset:0
    ds_read_b64_tr_b16 v[54:55], v14 offset:4736
    ds_read_b64_tr_b16 v[56:57], v14 offset:32
    ds_read_b64_tr_b16 v[58:59], v14 offset:4768
    ds_read_b64_tr_b16 v[60:61], v14 offset:64
    ds_read_b64_tr_b16 v[62:63], v14 offset:4800
    ds_read_b64_tr_b16 v[64:65], v14 offset:96
    ds_read_b64_tr_b16 v[66:67], v14 offset:4832
    ds_read_b64_tr_b16 v[68:69], v14 offset:128
    ds_read_b64_tr_b16 v[70:71], v14 offset:4864
    ds_read_b64_tr_b16 v[72:73], v14 offset:160
    ds_read_b64_tr_b16 v[74:75], v14 offset:4896
    ds_read_b64_tr_b16 v[76:77], v14 offset:192
    ds_read_b64_tr_b16 v[78:79], v14 offset:4928
    ds_read_b64_tr_b16 v[80:81], v14 offset:224
    ds_read_b64_tr_b16 v[82:83], v14 offset:4960
    ds_read_b64_tr_b16 v[84:85], v14 offset:256
    ds_read_b64_tr_b16 v[86:87], v14 offset:4992
    s_waitcnt lgkmcnt(15)
    s_mov_b32 s36, 2359296
    buffer_store_dwordx4 v[52:55], v8, s[4:7], s36 offen
    s_waitcnt lgkmcnt(14)
    s_mov_b32 s36, 2360320
    buffer_store_dwordx4 v[56:59], v8, s[4:7], s36 offen
    s_waitcnt lgkmcnt(12)
    s_mov_b32 s36, 2361344
    buffer_store_dwordx4 v[60:63], v8, s[4:7], s36 offen
    s_waitcnt lgkmcnt(10)
    s_mov_b32 s36, 2362368
    buffer_store_dwordx4 v[64:67], v8, s[4:7], s36 offen
    s_waitcnt lgkmcnt(8)
    s_mov_b32 s36, 2363392
    buffer_store_dwordx4 v[68:71], v8, s[4:7], s36 offen
    s_waitcnt lgkmcnt(6)
    s_mov_b32 s36, 2364416
    buffer_store_dwordx4 v[72:75], v8, s[4:7], s36 offen
    s_waitcnt lgkmcnt(4)
    s_mov_b32 s36, 2365440
    buffer_store_dwordx4 v[76:79], v8, s[4:7], s36 offen
    s_waitcnt lgkmcnt(2)
    s_mov_b32 s36, 2366464
    buffer_store_dwordx4 v[80:83], v8, s[4:7], s36 offen
    s_waitcnt lgkmcnt(0)
    s_mov_b32 s36, 2367488
    buffer_store_dwordx4 v[84:87], v8, s[4:7], s36 offen
    s_branch L_prep_fin
L_mod:
    s_load_dwordx2 s[20:21], s[0:1], 96
    s_load_dwordx2 s[22:23], s[0:1], 104
    s_sub_u32 s34, s2, 640
    s_mul_i32 s35, s34, 2428
    s_lshr_b32 s35, s35, 16
    s_mul_i32 s36, s35, 27
    s_sub_u32 s36, s34, s36
    v_and_b32 v3, 15, v0
    v_lshrrev_b32 v4, 4, v0
    s_lshl_b32 s37, s35, 6
    v_add_u32 v5, s37, v4
    v_mul_u32_u24 v6, 6912, v5
    v_lshlrev_b32 v7, 4, v3
    v_add_u32 v6, v6, v7
    s_lshl_b32 s37, s36, 8
    v_add_u32 v6, s37, v6
    v_lshlrev_b32 v5, 1, v5
    s_waitcnt lgkmcnt(0)
    s_mov_b32 s4, s26
    s_mov_b32 s5, s27
    s_mov_b32 s6, 268435456
    s_mov_b32 s7, 0x20000
    s_mov_b32 s8, s20
    s_mov_b32 s9, s21
    s_mov_b32 s10, 1152
    s_mov_b32 s11, 0x20000
    s_mov_b32 s12, s22
    s_mov_b32 s13, s23
    s_mov_b32 s14, 3981312
    s_mov_b32 s15, 0x20000
    buffer_load_ushort v32, v5, s[8:11], 0 offen offset:0
    buffer_load_ushort v33, v5, s[8:11], 0 offen offset:32
    buffer_load_ushort v34, v5, s[8:11], 0 offen offset:64
    buffer_load_ushort v35, v5, s[8:11], 0 offen offset:96
    s_waitcnt vmcnt(0)
    s_mov_b32 s38, 0
    buffer_load_dwordx4 v[16:19], v6, s[12:15], s38 offen
    s_mov_b32 s38, 110592
    buffer_load_dwordx4 v[20:23], v6, s[12:15], s38 offen
    s_mov_b32 s38, 221184
    buffer_load_dwordx4 v[24:27], v6, s[12:15], s38 offen
    s_mov_b32 s38, 331776
    buffer_load_dwordx4 v[28:31], v6, s[12:15], s38 offen
    v_lshlrev_b32 v32, 16, v32
    v_lshlrev_b32 v33, 16, v33
    v_lshlrev_b32 v34, 16, v34
    v_lshlrev_b32 v35, 16, v35
    v_mul_f32 v36, 0xbfb8aa3b, v32
    v_mul_f32 v37, 0xbfb8aa3b, v33
    v_mul_f32 v38, 0xbfb8aa3b, v34
    v_mul_f32 v39, 0xbfb8aa3b, v35
    v_exp_f32 v36, v36
    v_exp_f32 v37, v37
    v_exp_f32 v38, v38
    v_exp_f32 v39, v39
    v_add_f32 v36, 1.0, v36
    v_add_f32 v37, 1.0, v37
    v_add_f32 v38, 1.0, v38
    v_add_f32 v39, 1.0, v39
    v_rcp_f32 v36, v36
    v_rcp_f32 v37, v37
    v_rcp_f32 v38, v38
    v_rcp_f32 v39, v39
    v_mul_f32 v32, v32, v36
    v_mul_f32 v33, v33, v37
    v_mul_f32 v34, v34, v38
    v_mul_f32 v35, v35, v39
    v_cvt_pk_bf16_f32 v32, v32, v32
    v_and_b32 v32, 0xffff0000, v32
    v_cvt_pk_bf16_f32 v33, v33, v33
    v_and_b32 v33, 0xffff0000, v33
    v_cvt_pk_bf16_f32 v34, v34, v34
    v_and_b32 v34, 0xffff0000, v34
    v_cvt_pk_bf16_f32 v35, v35, v35
    v_and_b32 v35, 0xffff0000, v35
    v_mov_b32 v40, 0
    v_mov_b32 v41, 0
    v_mov_b32 v42, 0
    v_mov_b32 v43, 0
    v_mov_b32 v44, 0
    v_mov_b32 v45, 0
    v_mov_b32 v46, 0
    v_mov_b32 v47, 0
    s_waitcnt vmcnt(0)
    v_lshlrev_b32 v48, 16, v16
    v_and_b32 v49, 0xffff0000, v16
    v_fmac_f32 v40, v48, v32
    v_fmac_f32 v41, v49, v32
    v_lshlrev_b32 v48, 16, v17
    v_and_b32 v49, 0xffff0000, v17
    v_fmac_f32 v42, v48, v32
    v_fmac_f32 v43, v49, v32
    v_lshlrev_b32 v48, 16, v18
    v_and_b32 v49, 0xffff0000, v18
    v_fmac_f32 v44, v48, v32
    v_fmac_f32 v45, v49, v32
    v_lshlrev_b32 v48, 16, v19
    v_and_b32 v49, 0xffff0000, v19
    v_fmac_f32 v46, v48, v32
    v_fmac_f32 v47, v49, v32
    v_lshlrev_b32 v48, 16, v20
    v_and_b32 v49, 0xffff0000, v20
    v_fmac_f32 v40, v48, v33
    v_fmac_f32 v41, v49, v33
    v_lshlrev_b32 v48, 16, v21
    v_and_b32 v49, 0xffff0000, v21
    v_fmac_f32 v42, v48, v33
    v_fmac_f32 v43, v49, v33
    v_lshlrev_b32 v48, 16, v22
    v_and_b32 v49, 0xffff0000, v22
    v_fmac_f32 v44, v48, v33
    v_fmac_f32 v45, v49, v33
    v_lshlrev_b32 v48, 16, v23
    v_and_b32 v49, 0xffff0000, v23
    v_fmac_f32 v46, v48, v33
    v_fmac_f32 v47, v49, v33
    v_lshlrev_b32 v48, 16, v24
    v_and_b32 v49, 0xffff0000, v24
    v_fmac_f32 v40, v48, v34
    v_fmac_f32 v41, v49, v34
    v_lshlrev_b32 v48, 16, v25
    v_and_b32 v49, 0xffff0000, v25
    v_fmac_f32 v42, v48, v34
    v_fmac_f32 v43, v49, v34
    v_lshlrev_b32 v48, 16, v26
    v_and_b32 v49, 0xffff0000, v26
    v_fmac_f32 v44, v48, v34
    v_fmac_f32 v45, v49, v34
    v_lshlrev_b32 v48, 16, v27
    v_and_b32 v49, 0xffff0000, v27
    v_fmac_f32 v46, v48, v34
    v_fmac_f32 v47, v49, v34
    v_lshlrev_b32 v48, 16, v28
    v_and_b32 v49, 0xffff0000, v28
    v_fmac_f32 v40, v48, v35
    v_fmac_f32 v41, v49, v35
    v_lshlrev_b32 v48, 16, v29
    v_and_b32 v49, 0xffff0000, v29
    v_fmac_f32 v42, v48, v35
    v_fmac_f32 v43, v49, v35
    v_lshlrev_b32 v48, 16, v30
    v_and_b32 v49, 0xffff0000, v30
    v_fmac_f32 v44, v48, v35
    v_fmac_f32 v45, v49, v35
    v_lshlrev_b32 v48, 16, v31
    v_and_b32 v49, 0xffff0000, v31
    v_fmac_f32 v46, v48, v35
    v_fmac_f32 v47, v49, v35
    v_lshlrev_b32 v6, 9, v4
    v_lshlrev_b32 v7, 5, v3
    v_add_u32 v6, v6, v7
    ds_write_b128 v6, v[40:43]
    ds_write_b128 v6, v[44:47] offset:16
    s_waitcnt lgkmcnt(0)
    s_barrier
    v_cmp_gt_u32 vcc, 128, v0
    v_lshlrev_b32 v6, 2, v0
    s_nop 0
    s_and_saveexec_b64 s[42:43], vcc
    s_cbranch_execz L_prep_fin
    ds_read_b32 v16, v6 offset:0
    ds_read_b32 v17, v6 offset:512
    ds_read_b32 v18, v6 offset:1024
    ds_read_b32 v19, v6 offset:1536
    ds_read_b32 v20, v6 offset:2048
    ds_read_b32 v21, v6 offset:2560
    ds_read_b32 v22, v6 offset:3072
    ds_read_b32 v23, v6 offset:3584
    ds_read_b32 v24, v6 offset:4096
    ds_read_b32 v25, v6 offset:4608
    ds_read_b32 v26, v6 offset:5120
    ds_read_b32 v27, v6 offset:5632
    ds_read_b32 v28, v6 offset:6144
    ds_read_b32 v29, v6 offset:6656
    ds_read_b32 v30, v6 offset:7168
    ds_read_b32 v31, v6 offset:7680
    s_waitcnt lgkmcnt(0)
    v_add_f32 v16, v16, v17
    v_add_f32 v16, v16, v18
    v_add_f32 v16, v16, v19
    v_add_f32 v16, v16, v20
    v_add_f32 v16, v16, v21
    v_add_f32 v16, v16, v22
    v_add_f32 v16, v16, v23
    v_add_f32 v16, v16, v24
    v_add_f32 v16, v16, v25
    v_add_f32 v16, v16, v26
    v_add_f32 v16, v16, v27
    v_add_f32 v16, v16, v28
    v_add_f32 v16, v16, v29
    v_add_f32 v16, v16, v30
    v_add_f32 v16, v16, v31
    s_mul_i32 s37, s35, 13824
    s_lshl_b32 s38, s36, 9
    s_add_u32 s37, s37, s38
    s_add_u32 s37, s37, 7340032
    buffer_store_dword v16, v6, s[4:7], s37 offen
    s_branch L_prep_fin
L_kgen:
    s_sub_u32 s2, s2, 64
    s_and_b32 s34, s2, 7
    s_lshr_b32 s2, s2, 3
    s_lshl_b32 s35, s34, 6
    s_add_u32 s35, s35, s2
    s_lshl_b32 s34, s34, 3
    s_add_u32 s34, s34, s2
    s_add_u32 s34, s34, 448
    s_cmp_lt_u32 s2, 64
    s_cselect_b32 s2, s35, s34
    s_load_dwordx2 s[8:9], s[0:1], 8
    s_load_dwordx2 s[12:13], s[0:1], 16
    s_load_dwordx2 s[16:17], s[0:1], 24
    s_load_dwordx2 s[28:29], s[0:1], 32
    s_load_dwordx2 s[20:21], s[0:1], 40
    v_and_b32 v3, 15, v1
    v_lshrrev_b32 v4, 4, v1
    v_and_b32 v6, 127, v0
    v_lshlrev_b32 v7, 1, v6
    s_lshl_b32 s35, s2, 8
    v_add_u32 v7, s35, v7
    s_and_b32 s34, s2, 0xfffffffe
    s_lshl_b32 s34, s34, 1
    s_waitcnt lgkmcnt(0)
    s_load_dword s36, s[20:21], s34
    s_mov_b32 s4, s26
    s_mov_b32 s5, s27
    s_mov_b32 s6, 268435456
    s_mov_b32 s7, 0x20000
    s_mov_b32 s10, 147456
    s_mov_b32 s11, 0x20000
    s_mov_b32 s14, 147456
    s_mov_b32 s15, 0x20000
    s_mov_b32 s18, 147456
    s_mov_b32 s19, 0x20000
    s_mov_b32 s30, 147456
    s_mov_b32 s31, 0x20000
    buffer_load_ushort v16, v7, s[8:11], 0 offen
    buffer_load_ushort v17, v7, s[12:15], 0 offen
    buffer_load_ushort v18, v7, s[16:19], 0 offen
    buffer_load_ushort v19, v7, s[28:31], 0 offen
    s_waitcnt lgkmcnt(0)
    s_bitcmp1_b32 s2, 0
    s_cselect_b32 s53, 0, 16
    s_lshl_b32 s36, s36, s53
    s_and_b32 s36, s36, 0xffff0000
    v_mov_b32 v10, s36
    v_mul_f32 v10, 0x3fb8aa3b, v10
    v_exp_f32 v10, v10
    s_nop 0
    v_cvt_pk_bf16_f32 v10, v10, v10
    v_and_b32 v10, 0xffff0000, v10
    v_lshlrev_b32 v11, 2, v6
    s_waitcnt vmcnt(0)
    v_lshlrev_b32 v16, 16, v16
    v_lshlrev_b32 v17, 16, v17
    v_lshlrev_b32 v18, 16, v18
    v_lshlrev_b32 v19, 16, v19
    v_mul_f32 v16, 0x3fb8aa3b, v16
    v_exp_f32 v16, v16
    s_nop 0
    v_cvt_pk_bf16_f32 v16, v16, v16
    v_and_b32 v16, 0xffff0000, v16
    v_mul_f32 v16, v16, v10
    v_mul_f32 v20, 0xbfb8aa3b, v16
    v_mul_f32 v17, v17, v10
    v_mul_f32 v21, 0x3e22f983, v17
    v_mul_f32 v18, v18, v10
    v_mul_f32 v19, v19, v10
    v_add_f32 v22, v18, v18
    v_add_f32 v23, v19, v19
    s_cmp_ge_u32 s33, 2
    s_cbranch_scc1 L_kg_b
    v_mul_f32 v24, 0x3f800000, v20
    v_mul_f32 v25, 0x3f800000, v21
    v_exp_f32 v24, v24
    v_fract_f32 v25, v25
    s_nop 0
    v_cos_f32 v26, v25
    v_sin_f32 v27, v25
    s_nop 0
    v_mul_f32 v32, v24, v26
    v_mul_f32 v33, v24, v27
    v_mul_f32 v24, 0x41000000, v20
    v_mul_f32 v25, 0x41000000, v21
    v_exp_f32 v24, v24
    v_fract_f32 v25, v25
    s_nop 0
    v_cos_f32 v26, v25
    v_sin_f32 v27, v25
    s_nop 0
    v_mul_f32 v46, v24, v26
    v_mul_f32 v47, v24, v27
    v_mul_f32 v24, 0x43000000, v20
    v_mul_f32 v25, 0x43000000, v21
    v_exp_f32 v24, v24
    v_fract_f32 v25, v25
    s_nop 0
    v_cos_f32 v26, v25
    v_sin_f32 v27, v25
    s_nop 0
    v_mul_f32 v48, v24, v26
    v_mul_f32 v49, v24, v27
    v_mov_b32 v50, 1.0
    v_mov_b32 v51, 0
    v_cvt_pk_bf16_f32 v28, v50, v51
    ds_write_b32 v11, v28 offset:0
    v_cvt_pk_bf16_f32 v29, v46, v47
    ds_write_b32 v11, v29 offset:528
    v_pk_mul_f32 v[50:51], v[46:47], v[46:47] op_sel:[0,0] op_sel_hi:[1,0]
    v_pk_fma_f32 v[50:51], v[46:47], v[46:47], v[50:51] op_sel:[1,1,0] op_sel_hi:[0,1,1] neg_lo:[1,0,0]
    v_cvt_pk_bf16_f32 v28, v50, v51
    ds_write_b32 v11, v28 offset:1056
    v_pk_mul_f32 v[34:35], v[32:33], v[32:33] op_sel:[0,0] op_sel_hi:[1,0]
    v_pk_fma_f32 v[34:35], v[32:33], v[32:33], v[34:35] op_sel:[1,1,0] op_sel_hi:[0,1,1] neg_lo:[1,0,0]
    v_pk_mul_f32 v[52:53], v[50:51], v[46:47] op_sel:[0,0] op_sel_hi:[1,0]
    v_pk_fma_f32 v[52:53], v[50:51], v[46:47], v[52:53] op_sel:[1,1,0] op_sel_hi:[0,1,1] neg_lo:[1,0,0]
    v_cvt_pk_bf16_f32 v29, v52, v53
    ds_write_b32 v11, v29 offset:1584
    v_pk_mul_f32 v[36:37], v[34:35], v[32:33] op_sel:[0,0] op_sel_hi:[1,0]
    v_pk_fma_f32 v[36:37], v[34:35], v[32:33], v[36:37] op_sel:[1,1,0] op_sel_hi:[0,1,1] neg_lo:[1,0,0]
    v_pk_mul_f32 v[50:51], v[52:53], v[46:47] op_sel:[0,0] op_sel_hi:[1,0]
    v_pk_fma_f32 v[50:51], v[52:53], v[46:47], v[50:51] op_sel:[1,1,0] op_sel_hi:[0,1,1] neg_lo:[1,0,0]
    v_cvt_pk_bf16_f32 v28, v50, v51
    ds_write_b32 v11, v28 offset:2112
    v_pk_mul_f32 v[38:39], v[36:37], v[32:33] op_sel:[0,0] op_sel_hi:[1,0]
    v_pk_fma_f32 v[38:39], v[36:37], v[32:33], v[38:39] op_sel:[1,1,0] op_sel_hi:[0,1,1] neg_lo:[1,0,0]
    v_pk_mul_f32 v[52:53], v[50:51], v[46:47] op_sel:[0,0] op_sel_hi:[1,0]
    v_pk_fma_f32 v[52:53], v[50:51], v[46:47], v[52:53] op_sel:[1,1,0] op_sel_hi:[0,1,1] neg_lo:[1,0,0]
    v_cvt_pk_bf16_f32 v29, v52, v53
    ds_write_b32 v11, v29 offset:2640
    v_pk_mul_f32 v[40:41], v[38:39], v[32:33] op_sel:[0,0] op_sel_hi:[1,0]
    v_pk_fma_f32 v[40:41], v[38:39], v[32:33], v[40:41] op_sel:[1,1,0] op_sel_hi:[0,1,1] neg_lo:[1,0,0]
    v_pk_mul_f32 v[50:51], v[52:53], v[46:47] op_sel:[0,0] op_sel_hi:[1,0]
    v_pk_fma_f32 v[50:51], v[52:53], v[46:47], v[50:51] op_sel:[1,1,0] op_sel_hi:[0,1,1] neg_lo:[1,0,0]
    v_cvt_pk_bf16_f32 v28, v50, v51
    ds_write_b32 v11, v28 offset:3168
    v_pk_mul_f32 v[42:43], v[40:41], v[32:33] op_sel:[0,0] op_sel_hi:[1,0]
    v_pk_fma_f32 v[42:43], v[40:41], v[32:33], v[42:43] op_sel:[1,1,0] op_sel_hi:[0,1,1] neg_lo:[1,0,0]
    v_pk_mul_f32 v[52:53], v[50:51], v[46:47] op_sel:[0,0] op_sel_hi:[1,0]
    v_pk_fma_f32 v[52:53], v[50:51], v[46:47], v[52:53] op_sel:[1,1,0] op_sel_hi:[0,1,1] neg_lo:[1,0,0]
    v_cvt_pk_bf16_f32 v29, v52, v53
    ds_write_b32 v11, v29 offset:3696
    v_pk_mul_f32 v[44:45], v[42:43], v[32:33] op_sel:[0,0] op_sel_hi:[1,0]
    v_pk_fma_f32 v[44:45], v[42:43], v[32:33], v[44:45] op_sel:[1,1,0] op_sel_hi:[0,1,1] neg_lo:[1,0,0]
    v_pk_mul_f32 v[50:51], v[52:53], v[46:47] op_sel:[0,0] op_sel_hi:[1,0]
    v_pk_fma_f32 v[50:51], v[52:53], v[46:47], v[50:51] op_sel:[1,1,0] op_sel_hi:[0,1,1] neg_lo:[1,0,0]
    v_cvt_pk_bf16_f32 v28, v50, v51
    ds_write_b32 v11, v28 offset:4224
    v_pk_mul_f32 v[52:53], v[50:51], v[46:47] op_sel:[0,0] op_sel_hi:[1,0]
    v_pk_fma_f32 v[52:53], v[50:51], v[46:47], v[52:53] op_sel:[1,1,0] op_sel_hi:[0,1,1] neg_lo:[1,0,0]
    v_cvt_pk_bf16_f32 v29, v52, v53
    ds_write_b32 v11, v29 offset:4752
    v_pk_mul_f32 v[50:51], v[52:53], v[46:47] op_sel:[0,0] op_sel_hi:[1,0]
    v_pk_fma_f32 v[50:51], v[52:53], v[46:47], v[50:51] op_sel:[1,1,0] op_sel_hi:[0,1,1] neg_lo:[1,0,0]
    v_cvt_pk_bf16_f32 v28, v50, v51
    ds_write_b32 v11, v28 offset:5280
    v_pk_mul_f32 v[52:53], v[50:51], v[46:47] op_sel:[0,0] op_sel_hi:[1,0]
    v_pk_fma_f32 v[52:53], v[50:51], v[46:47], v[52:53] op_sel:[1,1,0] op_sel_hi:[0,1,1] neg_lo:[1,0,0]
    v_cvt_pk_bf16_f32 v29, v52, v53
    ds_write_b32 v11, v29 offset:5808
    v_pk_mul_f32 v[50:51], v[52:53], v[46:47] op_sel:[0,0] op_sel_hi:[1,0]
    v_pk_fma_f32 v[50:51], v[52:53], v[46:47], v[50:51] op_sel:[1,1,0] op_sel_hi:[0,1,1] neg_lo:[1,0,0]
    v_cvt_pk_bf16_f32 v28, v50, v51
    ds_write_b32 v11, v28 offset:6336
    v_pk_mul_f32 v[52:53], v[50:51], v[46:47] op_sel:[0,0] op_sel_hi:[1,0]
    v_pk_fma_f32 v[52:53], v[50:51], v[46:47], v[52:53] op_sel:[1,1,0] op_sel_hi:[0,1,1] neg_lo:[1,0,0]
    v_cvt_pk_bf16_f32 v29, v52, v53
    ds_write_b32 v11, v29 offset:6864
    v_pk_mul_f32 v[50:51], v[52:53], v[46:47] op_sel:[0,0] op_sel_hi:[1,0]
    v_pk_fma_f32 v[50:51], v[52:53], v[46:47], v[50:51] op_sel:[1,1,0] op_sel_hi:[0,1,1] neg_lo:[1,0,0]
    v_cvt_pk_bf16_f32 v28, v50, v51
    ds_write_b32 v11, v28 offset:7392
    v_pk_mul_f32 v[52:53], v[50:51], v[46:47] op_sel:[0,0] op_sel_hi:[1,0]
    v_pk_fma_f32 v[52:53], v[50:51], v[46:47], v[52:53] op_sel:[1,1,0] op_sel_hi:[0,1,1] neg_lo:[1,0,0]
    v_cvt_pk_bf16_f32 v29, v52, v53
    ds_write_b32 v11, v29 offset:7920
    v_pk_mul_f32 v[56:57], v[22:23], v[48:49] op_sel:[0,0] op_sel_hi:[1,0]
    v_pk_fma_f32 v[56:57], v[22:23], v[48:49], v[56:57] op_sel:[1,1,0] op_sel_hi:[0,1,1] neg_lo:[1,0,0]
    v_cvt_pk_bf16_f32 v28, v22, -v23
    ds_write_b32 v11, v28 offset:8448
    v_pk_mul_f32 v[52:53], v[22:23], v[32:33] op_sel:[0,0] op_sel_hi:[1,0]
    v_pk_fma_f32 v[52:53], v[22:23], v[32:33], v[52:53] op_sel:[1,1,0] op_sel_hi:[0,1,1] neg_lo:[1,0,0]
    v_cvt_pk_bf16_f32 v29, v52, -v53
    ds_write_b32 v11, v29 offset:8976
    v_pk_mul_f32 v[50:51], v[22:23], v[34:35] op_sel:[0,0] op_sel_hi:[1,0]
    v_pk_fma_f32 v[50:51], v[22:23], v[34:35], v[50:51] op_sel:[1,1,0] op_sel_hi:[0,1,1] neg_lo:[1,0,0]
    v_cvt_pk_bf16_f32 v28, v50, -v51
    ds_write_b32 v11, v28 offset:9504
    v_pk_mul_f32 v[52:53], v[22:23], v[36:37] op_sel:[0,0] op_sel_hi:[1,0]
    v_pk_fma_f32 v[52:53], v[22:23], v[36:37], v[52:53] op_sel:[1,1,0] op_sel_hi:[0,1,1] neg_lo:[1,0,0]
    v_cvt_pk_bf16_f32 v29, v52, -v53
    ds_write_b32 v11, v29 offset:10032
    v_pk_mul_f32 v[50:51], v[22:23], v[38:39] op_sel:[0,0] op_sel_hi:[1,0]
    v_pk_fma_f32 v[50:51], v[22:23], v[38:39], v[50:51] op_sel:[1,1,0] op_sel_hi:[0,1,1] neg_lo:[1,0,0]
    v_cvt_pk_bf16_f32 v28, v50, -v51
    ds_write_b32 v11, v28 offset:10560
    v_pk_mul_f32 v[52:53], v[22:23], v[40:41] op_sel:[0,0] op_sel_hi:[1,0]
    v_pk_fma_f32 v[52:53], v[22:23], v[40:41], v[52:53] op_sel:[1,1,0] op_sel_hi:[0,1,1] neg_lo:[1,0,0]
    v_cvt_pk_bf16_f32 v29, v52, -v53
    ds_write_b32 v11, v29 offset:11088
    v_pk_mul_f32 v[50:51], v[22:23], v[42:43] op_sel:[0,0] op_sel_hi:[1,0]
    v_pk_fma_f32 v[50:51], v[22:23], v[42:43], v[50:51] op_sel:[1,1,0] op_sel_hi:[0,1,1] neg_lo:[1,0,0]
    v_cvt_pk_bf16_f32 v28, v50, -v51
    ds_write_b32 v11, v28 offset:11616
    v_pk_mul_f32 v[52:53], v[22:23], v[44:45] op_sel:[0,0] op_sel_hi:[1,0]
    v_pk_fma_f32 v[52:53], v[22:23], v[44:45], v[52:53] op_sel:[1,1,0] op_sel_hi:[0,1,1] neg_lo:[1,0,0]
    v_cvt_pk_bf16_f32 v29, v52, -v53
    ds_write_b32 v11, v29 offset:12144
    v_cvt_pk_bf16_f32 v28, v56, -v57
    ds_write_b32 v11, v28 offset:12672
    v_pk_mul_f32 v[52:53], v[56:57], v[32:33] op_sel:[0,0] op_sel_hi:[1,0]
    v_pk_fma_f32 v[52:53], v[56:57], v[32:33], v[52:53] op_sel:[1,1,0] op_sel_hi:[0,1,1] neg_lo:[1,0,0]
    v_cvt_pk_bf16_f32 v29, v52, -v53
    ds_write_b32 v11, v29 offset:13200
    v_pk_mul_f32 v[50:51], v[56:57], v[34:35] op_sel:[0,0] op_sel_hi:[1,0]
    v_pk_fma_f32 v[50:51], v[56:57], v[34:35], v[50:51] op_sel:[1,1,0] op_sel_hi:[0,1,1] neg_lo:[1,0,0]
    v_cvt_pk_bf16_f32 v28, v50, -v51
    ds_write_b32 v11, v28 offset:13728
    v_pk_mul_f32 v[52:53], v[56:57], v[36:37] op_sel:[0,0] op_sel_hi:[1,0]
    v_pk_fma_f32 v[52:53], v[56:57], v[36:37], v[52:53] op_sel:[1,1,0] op_sel_hi:[0,1,1] neg_lo:[1,0,0]
    v_cvt_pk_bf16_f32 v29, v52, -v53
    ds_write_b32 v11, v29 offset:14256
    v_pk_mul_f32 v[50:51], v[56:57], v[38:39] op_sel:[0,0] op_sel_hi:[1,0]
    v_pk_fma_f32 v[50:51], v[56:57], v[38:39], v[50:51] op_sel:[1,1,0] op_sel_hi:[0,1,1] neg_lo:[1,0,0]
    v_cvt_pk_bf16_f32 v28, v50, -v51
    ds_write_b32 v11, v28 offset:14784
    v_pk_mul_f32 v[52:53], v[56:57], v[40:41] op_sel:[0,0] op_sel_hi:[1,0]
    v_pk_fma_f32 v[52:53], v[56:57], v[40:41], v[52:53] op_sel:[1,1,0] op_sel_hi:[0,1,1] neg_lo:[1,0,0]
    v_cvt_pk_bf16_f32 v29, v52, -v53
    ds_write_b32 v11, v29 offset:15312
    v_pk_mul_f32 v[50:51], v[56:57], v[42:43] op_sel:[0,0] op_sel_hi:[1,0]
    v_pk_fma_f32 v[50:51], v[56:57], v[42:43], v[50:51] op_sel:[1,1,0] op_sel_hi:[0,1,1] neg_lo:[1,0,0]
    v_cvt_pk_bf16_f32 v28, v50, -v51
    ds_write_b32 v11, v28 offset:15840
    v_pk_mul_f32 v[52:53], v[56:57], v[44:45] op_sel:[0,0] op_sel_hi:[1,0]
    v_pk_fma_f32 v[52:53], v[56:57], v[44:45], v[52:53] op_sel:[1,1,0] op_sel_hi:[0,1,1] neg_lo:[1,0,0]
    v_cvt_pk_bf16_f32 v29, v52, -v53
    ds_write_b32 v11, v29 offset:16368
    s_branch L_kg_done
L_kg_b:
    v_mul_f32 v24, 0x40000000, v20
    v_mul_f32 v25, 0x40000000, v21
    v_exp_f32 v24, v24
    v_fract_f32 v25, v25
    s_nop 0
    v_cos_f32 v26, v25
    v_sin_f32 v27, v25
    s_nop 0
    v_mul_f32 v32, v24, v26
    v_mul_f32 v33, v24, v27
    v_mul_f32 v24, 0x43000000, v20
    v_mul_f32 v25, 0x43000000, v21
    v_exp_f32 v24, v24
    v_fract_f32 v25, v25
    s_nop 0
    v_cos_f32 v26, v25
    v_sin_f32 v27, v25
    s_nop 0
    v_mul_f32 v48, v24, v26
    v_mul_f32 v49, v24, v27
    v_mul_f32 v24, 0x43800000, v20
    v_mul_f32 v25, 0x43800000, v21
    v_exp_f32 v24, v24
    v_fract_f32 v25, v25
    s_nop 0
    v_cos_f32 v26, v25
    v_sin_f32 v27, v25
    s_nop 0
    v_mul_f32 v50, v24, v26
    v_mul_f32 v51, v24, v27
    v_pk_mul_f32 v[34:35], v[32:33], v[32:33] op_sel:[0,0] op_sel_hi:[1,0]
    v_pk_fma_f32 v[34:35], v[32:33], v[32:33], v[34:35] op_sel:[1,1,0] op_sel_hi:[0,1,1] neg_lo:[1,0,0]
    v_pk_mul_f32 v[54:55], v[22:23], v[50:51] op_sel:[0,0] op_sel_hi:[1,0]
    v_pk_fma_f32 v[54:55], v[22:23], v[50:51], v[54:55] op_sel:[1,1,0] op_sel_hi:[0,1,1] neg_lo:[1,0,0]
    v_pk_mul_f32 v[36:37], v[34:35], v[32:33] op_sel:[0,0] op_sel_hi:[1,0]
    v_pk_fma_f32 v[36:37], v[34:35], v[32:33], v[36:37] op_sel:[1,1,0] op_sel_hi:[0,1,1] neg_lo:[1,0,0]
    v_cvt_pk_bf16_f32 v28, v54, -v55
    ds_write_b32 v11, v28 offset:16896
    v_pk_mul_f32 v[52:53], v[54:55], v[32:33] op_sel:[0,0] op_sel_hi:[1,0]
    v_pk_fma_f32 v[52:53], v[54:55], v[32:33], v[52:53] op_sel:[1,1,0] op_sel_hi:[0,1,1] neg_lo:[1,0,0]
    v_cvt_pk_bf16_f32 v29, v52, -v53
    ds_write_b32 v11, v29 offset:17424
    v_pk_mul_f32 v[50:51], v[54:55], v[34:35] op_sel:[0,0] op_sel_hi:[1,0]
    v_pk_fma_f32 v[50:51], v[54:55], v[34:35], v[50:51] op_sel:[1,1,0] op_sel_hi:[0,1,1] neg_lo:[1,0,0]
    v_cvt_pk_bf16_f32 v28, v50, -v51
    ds_write_b32 v11, v28 offset:17952
    v_pk_mul_f32 v[52:53], v[54:55], v[36:37] op_sel:[0,0] op_sel_hi:[1,0]
    v_pk_fma_f32 v[52:53], v[54:55], v[36:37], v[52:53] op_sel:[1,1,0] op_sel_hi:[0,1,1] neg_lo:[1,0,0]
    v_cvt_pk_bf16_f32 v29, v52, -v53
    ds_write_b32 v11, v29 offset:18480
    v_pk_mul_f32 v[56:57], v[54:55], v[48:49] op_sel:[0,0] op_sel_hi:[1,0]
    v_pk_fma_f32 v[56:57], v[54:55], v[48:49], v[56:57] op_sel:[1,1,0] op_sel_hi:[0,1,1] neg_lo:[1,0,0]
    v_cvt_pk_bf16_f32 v28, v56, -v57
    ds_write_b32 v11, v28 offset:19008
    v_pk_mul_f32 v[52:53], v[56:57], v[32:33] op_sel:[0,0] op_sel_hi:[1,0]
    v_pk_fma_f32 v[52:53], v[56:57], v[32:33], v[52:53] op_sel:[1,1,0] op_sel_hi:[0,1,1] neg_lo:[1,0,0]
    v_cvt_pk_bf16_f32 v29, v52, -v53
    ds_write_b32 v11, v29 offset:19536
    v_pk_mul_f32 v[50:51], v[56:57], v[34:35] op_sel:[0,0] op_sel_hi:[1,0]
    v_pk_fma_f32 v[50:51], v[56:57], v[34:35], v[50:51] op_sel:[1,1,0] op_sel_hi:[0,1,1] neg_lo:[1,0,0]
    v_cvt_pk_bf16_f32 v28, v50, -v51
    ds_write_b32 v11, v28 offset:20064
    v_pk_mul_f32 v[52:53], v[56:57], v[36:37] op_sel:[0,0] op_sel_hi:[1,0]
    v_pk_fma_f32 v[52:53], v[56:57], v[36:37], v[52:53] op_sel:[1,1,0] op_sel_hi:[0,1,1] neg_lo:[1,0,0]
    v_cvt_pk_bf16_f32 v29, v52, -v53
    ds_write_b32 v11, v29 offset:20592
    v_pk_mul_f32 v[54:55], v[56:57], v[48:49] op_sel:[0,0] op_sel_hi:[1,0]
    v_pk_fma_f32 v[54:55], v[56:57], v[48:49], v[54:55] op_sel:[1,1,0] op_sel_hi:[0,1,1] neg_lo:[1,0,0]
    v_cvt_pk_bf16_f32 v28, v54, -v55
    ds_write_b32 v11, v28 offset:21120
    v_pk_mul_f32 v[52:53], v[54:55], v[34:35] op_sel:[0,0] op_sel_hi:[1,0]
    v_pk_fma_f32 v[52:53], v[54:55], v[34:35], v[52:53] op_sel:[1,1,0] op_sel_hi:[0,1,1] neg_lo:[1,0,0]
    v_cvt_pk_bf16_f32 v29, v52, -v53
    ds_write_b32 v11, v29 offset:21648
    v_pk_mul_f32 v[56:57], v[54:55], v[48:49] op_sel:[0,0] op_sel_hi:[1,0]
    v_pk_fma_f32 v[56:57], v[54:55], v[48:49], v[56:57] op_sel:[1,1,0] op_sel_hi:[0,1,1] neg_lo:[1,0,0]
    v_cvt_pk_bf16_f32 v28, v56, -v57
    ds_write_b32 v11, v28 offset:22176
    v_pk_mul_f32 v[52:53], v[56:57], v[34:35] op_sel:[0,0] op_sel_hi:[1,0]
    v_pk_fma_f32 v[52:53], v[56:57], v[34:35], v[52:53] op_sel:[1,1,0] op_sel_hi:[0,1,1] neg_lo:[1,0,0]
    v_cvt_pk_bf16_f32 v29, v52, -v53
    ds_write_b32 v11, v29 offset:22704
    v_pk_mul_f32 v[54:55], v[56:57], v[48:49] op_sel:[0,0] op_sel_hi:[1,0]
    v_pk_fma_f32 v[54:55], v[56:57], v[48:49], v[54:55] op_sel:[1,1,0] op_sel_hi:[0,1,1] neg_lo:[1,0,0]
    v_cvt_pk_bf16_f32 v28, v54, -v55
    ds_write_b32 v11, v28 offset:23232
    v_pk_mul_f32 v[52:53], v[54:55], v[34:35] op_sel:[0,0] op_sel_hi:[1,0]
    v_pk_fma_f32 v[52:53], v[54:55], v[34:35], v[52:53] op_sel:[1,1,0] op_sel_hi:[0,1,1] neg_lo:[1,0,0]
    v_cvt_pk_bf16_f32 v29, v52, -v53
    ds_write_b32 v11, v29 offset:23760
    v_pk_mul_f32 v[56:57], v[54:55], v[48:49] op_sel:[0,0] op_sel_hi:[1,0]
    v_pk_fma_f32 v[56:57], v[54:55], v[48:49], v[56:57] op_sel:[1,1,0] op_sel_hi:[0,1,1] neg_lo:[1,0,0]
    v_cvt_pk_bf16_f32 v28, v56, -v57
    ds_write_b32 v11, v28 offset:24288
    v_pk_mul_f32 v[52:53], v[56:57], v[34:35] op_sel:[0,0] op_sel_hi:[1,0]
    v_pk_fma_f32 v[52:53], v[56:57], v[34:35], v[52:53] op_sel:[1,1,0] op_sel_hi:[0,1,1] neg_lo:[1,0,0]
    v_cvt_pk_bf16_f32 v29, v52, -v53
    ds_write_b32 v11, v29 offset:24816
    v_pk_mul_f32 v[54:55], v[56:57], v[48:49] op_sel:[0,0] op_sel_hi:[1,0]
    v_pk_fma_f32 v[54:55], v[56:57], v[48:49], v[54:55] op_sel:[1,1,0] op_sel_hi:[0,1,1] neg_lo:[1,0,0]
    v_cvt_pk_bf16_f32 v28, v54, -v55
    ds_write_b32 v11, v28 offset:25344
    v_pk_mul_f32 v[56:57], v[54:55], v[48:49] op_sel:[0,0] op_sel_hi:[1,0]
    v_pk_fma_f32 v[56:57], v[54:55], v[48:49], v[56:57] op_sel:[1,1,0] op_sel_hi:[0,1,1] neg_lo:[1,0,0]
    v_cvt_pk_bf16_f32 v29, v56, -v57
    ds_write_b32 v11, v29 offset:25872
    v_pk_mul_f32 v[54:55], v[56:57], v[48:49] op_sel:[0,0] op_sel_hi:[1,0]
    v_pk_fma_f32 v[54:55], v[56:57], v[48:49], v[54:55] op_sel:[1,1,0] op_sel_hi:[0,1,1] neg_lo:[1,0,0]
    v_cvt_pk_bf16_f32 v28, v54, -v55
    ds_write_b32 v11, v28 offset:26400
    v_pk_mul_f32 v[56:57], v[54:55], v[48:49] op_sel:[0,0] op_sel_hi:[1,0]
    v_pk_fma_f32 v[56:57], v[54:55], v[48:49], v[56:57] op_sel:[1,1,0] op_sel_hi:[0,1,1] neg_lo:[1,0,0]
    v_cvt_pk_bf16_f32 v29, v56, -v57
    ds_write_b32 v11, v29 offset:26928
    v_pk_mul_f32 v[54:55], v[56:57], v[48:49] op_sel:[0,0] op_sel_hi:[1,0]
    v_pk_fma_f32 v[54:55], v[56:57], v[48:49], v[54:55] op_sel:[1,1,0] op_sel_hi:[0,1,1] neg_lo:[1,0,0]
    v_cvt_pk_bf16_f32 v28, v54, -v55
    ds_write_b32 v11, v28 offset:27456
    v_pk_mul_f32 v[56:57], v[54:55], v[48:49] op_sel:[0,0] op_sel_hi:[1,0]
    v_pk_fma_f32 v[56:57], v[54:55], v[48:49], v[56:57] op_sel:[1,1,0] op_sel_hi:[0,1,1] neg_lo:[1,0,0]
    v_cvt_pk_bf16_f32 v29, v56, -v57
    ds_write_b32 v11, v29 offset:27984
    v_pk_mul_f32 v[54:55], v[56:57], v[48:49] op_sel:[0,0] op_sel_hi:[1,0]
    v_pk_fma_f32 v[54:55], v[56:57], v[48:49], v[54:55] op_sel:[1,1,0] op_sel_hi:[0,1,1] neg_lo:[1,0,0]
    v_cvt_pk_bf16_f32 v28, v54, -v55
    ds_write_b32 v11, v28 offset:28512
    v_pk_mul_f32 v[56:57], v[54:55], v[48:49] op_sel:[0,0] op_sel_hi:[1,0]
    v_pk_fma_f32 v[56:57], v[54:55], v[48:49], v[56:57] op_sel:[1,1,0] op_sel_hi:[0,1,1] neg_lo:[1,0,0]
    v_cvt_pk_bf16_f32 v29, v56, -v57
    ds_write_b32 v11, v29 offset:29040
    v_pk_mul_f32 v[54:55], v[56:57], v[48:49] op_sel:[0,0] op_sel_hi:[1,0]
    v_pk_fma_f32 v[54:55], v[56:57], v[48:49], v[54:55] op_sel:[1,1,0] op_sel_hi:[0,1,1] neg_lo:[1,0,0]
    v_cvt_pk_bf16_f32 v28, v54, -v55
    ds_write_b32 v11, v28 offset:29568
L_kg_done:
    s_waitcnt lgkmcnt(0)
    s_barrier
    v_mul_u32_u24 v12, 528, v3
    v_lshlrev_b32 v13, 4, v4
    v_add_u32 v12, v12, v13
    s_mul_i32 s52, s33, 8448
    s_add_u32 s52, s52, 8448
    v_add_u32 v13, s52, v12
    s_cmp_lt_u32 s33, 3
    s_cbranch_scc0 L_nomm
    ds_read_b128 v[32:35], v13 offset:0
    ds_read_b128 v[36:39], v12 offset:0
    ds_read_b128 v[40:43], v13 offset:64
    ds_read_b128 v[44:47], v12 offset:64
    ds_read_b128 v[48:51], v13 offset:128
    ds_read_b128 v[52:55], v12 offset:128
    ds_read_b128 v[56:59], v13 offset:192
    ds_read_b128 v[60:63], v12 offset:192
    ds_read_b128 v[64:67], v13 offset:256
    ds_read_b128 v[68:71], v12 offset:256
    ds_read_b128 v[72:75], v13 offset:320
    ds_read_b128 v[76:79], v12 offset:320
    ds_read_b128 v[80:83], v13 offset:384
    ds_read_b128 v[84:87], v12 offset:384
    ds_read_b128 v[88:91], v13 offset:448
    ds_read_b128 v[92:95], v12 offset:448
    s_waitcnt lgkmcnt(14)
    v_mfma_f32_16x16x32_bf16 v[96:99], v[32:35], v[36:39], 0
    s_waitcnt lgkmcnt(12)
    v_mfma_f32_16x16x32_bf16 v[96:99], v[40:43], v[44:47], v[96:99]
    s_waitcnt lgkmcnt(10)
    v_mfma_f32_16x16x32_bf16 v[96:99], v[48:51], v[52:55], v[96:99]
    s_waitcnt lgkmcnt(8)
    v_mfma_f32_16x16x32_bf16 v[96:99], v[56:59], v[60:63], v[96:99]
    s_waitcnt lgkmcnt(6)
    v_mfma_f32_16x16x32_bf16 v[96:99], v[64:67], v[68:71], v[96:99]
    s_waitcnt lgkmcnt(4)
    v_mfma_f32_16x16x32_bf16 v[96:99], v[72:75], v[76:79], v[96:99]
    s_waitcnt lgkmcnt(2)
    v_mfma_f32_16x16x32_bf16 v[96:99], v[80:83], v[84:87], v[96:99]
    s_waitcnt lgkmcnt(0)
    v_mfma_f32_16x16x32_bf16 v[96:99], v[88:91], v[92:95], v[96:99]
L_nomm:
    s_barrier
    v_lshlrev_b32 v9, 4, v3
    s_cmp_lt_u32 s33, 3
    s_cbranch_scc0 L_notab
    s_cmp_eq_u32 s33, 1
    s_cbranch_scc1 L_tab1
    s_cmp_eq_u32 s33, 2
    s_cbranch_scc1 L_tab2
    v_lshrrev_b32 v14, 1, v4
    v_lshlrev_b32 v14, 8, v14
    v_and_b32 v15, 1, v4
    v_lshlrev_b32 v15, 3, v15
    v_add_u32 v14, v14, v15
    v_add_u32 v14, v14, v9
    v_cvt_pk_bf16_f32 v24, v96, v96
    ds_write_b16 v14, v24 offset:8
    v_cvt_pk_bf16_f32 v25, v97, v97
    ds_write_b16 v14, v25 offset:10
    v_cvt_pk_bf16_f32 v26, v98, v98
    ds_write_b16 v14, v26 offset:12
    v_cvt_pk_bf16_f32 v27, v99, v99
    ds_write_b16 v14, v27 offset:14
    s_branch L_notab
L_tab1:
    v_cmp_gt_u32 vcc, 2, v4
    v_lshlrev_b32 v14, 8, v4
    v_add_u32 v14, 512, v14
    v_lshlrev_b32 v15, 9, v4
    v_cndmask_b32 v14, v15, v14, vcc
    v_add_u32 v14, v14, v9
    v_mov_b32 v15, 0
    v_cndmask_b32 v15, v15, 0, vcc
    v_add_u32 v15, v15, v14
    v_cvt_pk_bf16_f32 v24, v96, v96
    ds_write_b16 v15, v24 offset:8
    v_mov_b32 v15, 8
    v_cndmask_b32 v15, v15, 4, vcc
    v_add_u32 v15, v15, v14
    v_cvt_pk_bf16_f32 v25, v97, v97
    ds_write_b16 v15, v25 offset:8
    v_mov_b32 v15, 256
    v_cndmask_b32 v15, v15, 8, vcc
    v_add_u32 v15, v15, v14
    v_cvt_pk_bf16_f32 v26, v98, v98
    ds_write_b16 v15, v26 offset:8
    v_mov_b32 v15, 264
    v_cndmask_b32 v15, v15, 12, vcc
    v_add_u32 v15, v15, v14
    v_cvt_pk_bf16_f32 v27, v99, v99
    ds_write_b16 v15, v27 offset:8
    s_branch L_notab
L_tab2:
    v_lshlrev_b32 v14, 2, v4
    v_add_u32 v14, 8, v14
    v_min_u32 v14, 17, v14
    v_lshlrev_b32 v14, 8, v14
    v_add_u32 v14, v14, v9
    v_cvt_pk_bf16_f32 v24, v96, v96
    ds_write_b16 v14, v24 offset:8
    v_lshlrev_b32 v14, 2, v4
    v_add_u32 v14, 9, v14
    v_min_u32 v14, 17, v14
    v_lshlrev_b32 v14, 8, v14
    v_add_u32 v14, v14, v9
    v_cvt_pk_bf16_f32 v25, v97, v97
    ds_write_b16 v14, v25 offset:8
    v_lshlrev_b32 v14, 2, v4
    v_add_u32 v14, 10, v14
    v_min_u32 v14, 17, v14
    v_lshlrev_b32 v14, 8, v14
    v_add_u32 v14, v14, v9
    v_cvt_pk_bf16_f32 v26, v98, v98
    ds_write_b16 v14, v26 offset:8
    v_lshlrev_b32 v14, 2, v4
    v_add_u32 v14, 11, v14
    v_min_u32 v14, 17, v14
    v_lshlrev_b32 v14, 8, v14
    v_add_u32 v14, v14, v9
    v_cvt_pk_bf16_f32 v27, v99, v99
    ds_write_b16 v14, v27 offset:8
L_notab:
    v_mov_b32 v14, 0
    v_mov_b32 v24, 0
    v_mov_b32 v25, 0
    v_cmp_eq_u32 vcc, 192, v0
    s_nop 1
    s_and_saveexec_b64 s[42:43], vcc
    ds_write_b64 v14, v[24:25]
    s_mov_b64 exec, s[42:43]
    s_waitcnt lgkmcnt(0)
    s_barrier
    v_lshlrev_b32 v14, 4, v0
    v_add_u32 v14, 14, v14
    v_cvt_f32_i32 v14, v14
    v_mov_b32 v15, 8
    v_mov_b32 v24, v14
    v_add_f32 v25, 0xc0000000, v14
    v_cvt_pk_bf16_f32 v26, v24, v25
    v_lshlrev_b32 v24, 16, v26
    v_and_b32 v25, 0xffff0000, v26
    v_cvt_i32_f32 v24, v24
    v_cvt_i32_f32 v25, v25
    v_add_u32 v24, v24, v15
    v_add_u32 v25, v25, v15
    ds_read_u16 v32, v24
    ds_read_u16 v33, v25
    v_add_f32 v24, 0xc0800000, v14
    v_add_f32 v25, 0xc0c00000, v14
    v_cvt_pk_bf16_f32 v26, v24, v25
    v_lshlrev_b32 v24, 16, v26
    v_and_b32 v25, 0xffff0000, v26
    v_cvt_i32_f32 v24, v24
    v_cvt_i32_f32 v25, v25
    v_add_u32 v24, v24, v15
    v_add_u32 v25, v25, v15
    ds_read_u16 v34, v24
    ds_read_u16 v35, v25
    v_add_f32 v24, 0xc1000000, v14
    v_add_f32 v25, 0xc1200000, v14
    v_cvt_pk_bf16_f32 v26, v24, v25
    v_lshlrev_b32 v24, 16, v26
    v_and_b32 v25, 0xffff0000, v26
    v_cvt_i32_f32 v24, v24
    v_cvt_i32_f32 v25, v25
    v_add_u32 v24, v24, v15
    v_add_u32 v25, v25, v15
    ds_read_u16 v36, v24
    ds_read_u16 v37, v25
    v_add_f32 v24, 0xc1400000, v14
    v_add_f32 v25, 0xc1600000, v14
    v_cvt_pk_bf16_f32 v26, v24, v25
    v_lshlrev_b32 v24, 16, v26
    v_and_b32 v25, 0xffff0000, v26
    v_cvt_i32_f32 v24, v24
    v_cvt_i32_f32 v25, v25
    v_add_u32 v24, v24, v15
    v_add_u32 v25, v25, v15
    ds_read_u16 v38, v24
    ds_read_u16 v39, v25
    s_mul_i32 s40, s2, 4352
    s_add_u32 s40, s40, 4718592
    v_sub_u32 v9, 255, v0
    v_lshlrev_b32 v9, 4, v9
    v_mov_b32 v44, 0
    v_mov_b32 v45, 0
    v_mov_b32 v46, 0
    v_mov_b32 v47, 0
    v_lshlrev_b32 v12, 4, v0
    v_cmp_gt_u32 vcc, 16, v0
    s_waitcnt lgkmcnt(0)
    v_lshl_or_b32 v48, v33, 16, v32
    v_lshl_or_b32 v49, v35, 16, v34
    v_lshl_or_b32 v50, v37, 16, v36
    v_lshl_or_b32 v51, v39, 16, v38
    buffer_store_dwordx4 v[48:51], v9, s[4:7], s40 offen
    s_and_saveexec_b64 s[42:43], vcc
    s_add_u32 s41, s40, 4096
    buffer_store_dwordx4 v[44:47], v12, s[4:7], s41 offen
    s_mov_b64 exec, s[42:43]
L_prep_fin:
    s_waitcnt vmcnt(0)
L_prep_end:
    s_endpgm
.section .rodata,"a"
.p2align 6
L_kd_prep_kernel:
.amdhsa_kernel prep_kernel
  .amdhsa_next_free_vgpr 128
  .amdhsa_next_free_sgpr 96
  .amdhsa_accum_offset 128
  .amdhsa_group_segment_fixed_size 0
  .amdhsa_kernarg_size 136
  .amdhsa_user_sgpr_count 2
  .amdhsa_user_sgpr_kernarg_segment_ptr 1
  .amdhsa_system_sgpr_workgroup_id_x 1
  .amdhsa_float_denorm_mode_32 3
.end_amdhsa_kernel

.text
.globl conv_kernel
.p2align 8
.type conv_kernel,@function
conv_kernel:
    s_cmp_ge_u32 s2, 256
    s_cbranch_scc1 L_conv_end
    s_mov_b32 s55, s2
    s_load_dwordx2 s[20:21], s[0:1], 48
    s_load_dwordx2 s[26:27], s[0:1], 128
    s_cmp_lt_u32 s55, 128
    s_cselect_b32 s54, 64, 80
    s_load_dwordx2 s[56:57], s[0:1], s54
    s_load_dwordx2 s[8:9], s[0:1], 72
    s_load_dwordx2 s[12:13], s[0:1], 88
    v_mov_b32 v42, v0
    v_lshrrev_b32 v2, 6, v0
    v_and_b32 v0, 255, v0
    v_and_b32 v1, 63, v0
    v_and_b32 v3, 15, v1
    v_lshrrev_b32 v4, 4, v1
    v_readfirstlane_b32 s33, v2
    s_nop 3
    s_lshr_b32 s34, s33, 2
    s_and_b32 s33, s33, 3
    s_mul_i32 s61, s34, 41472
    s_and_b32 s48, s55, 7
    s_lshr_b32 s49, s55, 3
    s_lshl_b32 s2, s48, 6
    s_lshl_b32 s50, s49, 1
    s_add_u32 s2, s2, s50
    s_add_u32 s2, s2, s34
    s_mov_b32 s62, 1
    s_mov_b32 s63, 1
    s_cmp_eq_u32 s34, 2
    s_cbranch_scc0 L_conv_whole
    s_cmp_ge_u32 s49, 16
    s_cbranch_scc1 L_conv_end
    s_lshl_b32 s2, s48, 3
    s_lshr_b32 s50, s49, 1
    s_add_u32 s2, s2, s50
    s_add_u32 s2, s2, 512
    s_and_b32 s62, s49, 1
    s_mov_b32 s63, 0
L_conv_whole:
    v_lshlrev_b32 v5, 4, v0
    s_waitcnt lgkmcnt(0)
    s_mov_b32 s4, s26
    s_mov_b32 s5, s27
    s_mov_b32 s6, 268435456
    s_mov_b32 s7, 0x20000
    s_and_b32 s34, s2, 0xfffffffe
    s_lshl_b32 s34, s34, 1
    s_load_dword s35, s[20:21], s34
    v_lshrrev_b32 v6, 2, v0
    v_mul_u32_u24 v6, 36864, v6
    v_and_b32 v7, 3, v0
    v_lshlrev_b32 v7, 4, v7
    v_add_u32 v30, v6, v7
    s_lshl_b32 s36, s2, 6
    s_add_u32 s37, s36, 2359296
    s_add_u32 s36, s36, 0
    buffer_load_dwordx4 v[16:19], v30, s[4:7], s37 offen
    s_mul_i32 s38, s2, 4352
    s_add_u32 s38, s38, 4718592
    buffer_load_dwordx4 v[24:27], v5, s[4:7], s38 offen
    buffer_load_dwordx2 v[28:29], v5, s[4:7], s38 offen offset:16
    v_mul_u32_u24 v6, 2304, v1
    s_lshl_b32 s39, s2, 2
    s_add_u32 s39, s39, 7340032
    v_cmp_gt_u32 vcc, 6, v1
    s_nop 1
    s_and_saveexec_b64 s[42:43], vcc
    s_add_u32 s40, s39, 0
    buffer_load_dword v32, v6, s[4:7], s40 offen
    s_add_u32 s40, s39, 13824
    buffer_load_dword v33, v6, s[4:7], s40 offen
    s_add_u32 s40, s39, 27648
    buffer_load_dword v34, v6, s[4:7], s40 offen
    s_add_u32 s40, s39, 41472
    buffer_load_dword v35, v6, s[4:7], s40 offen
    s_add_u32 s40, s39, 55296
    buffer_load_dword v36, v6, s[4:7], s40 offen
    s_add_u32 s40, s39, 69120
    buffer_load_dword v37, v6, s[4:7], s40 offen
    s_add_u32 s40, s39, 82944
    buffer_load_dword v38, v6, s[4:7], s40 offen
    s_add_u32 s40, s39, 96768
    buffer_load_dword v39, v6, s[4:7], s40 offen
    s_add_u32 s40, s39, 110592
    buffer_load_dword v40, v6, s[4:7], s40 offen
    s_mov_b64 exec, s[42:43]
    s_cmp_lt_u32 s55, 8
    s_cbranch_scc0 L_conv_nocpf
    s_getpc_b64 s[48:49]
L_conv_pc:
    s_sub_u32 s48, s48, L_conv_pc - conv_kernel
    s_subb_u32 s49, s49, 0
    v_lshlrev_b32 v44, 7, v42
    v_cmp_gt_u32 vcc, L_mlp_end - conv_kernel, v44
    v_mov_b32 v47, s49
    v_add_co_u32 v46, s[50:51], s48, v44
    s_nop 1
    v_addc_co_u32 v47, s[50:51], 0, v47, s[50:51]
    s_and_saveexec_b64 s[52:53], vcc
    global_load_dword v41, v[46:47], off
    s_mov_b64 exec, s[52:53]
L_conv_nocpf:
    s_cmp_lt_u32 s2, 32
    s_cbranch_scc0 L_conv_nofl
    s_lshl_b32 s40, s2, 7
    s_add_u32 s40, s40, 12320768
    v_mov_b32 v44, 0
    v_lshlrev_b32 v7, 2, v0
    v_cmp_gt_u32 vcc, 32, v0
    s_nop 1
    s_and_saveexec_b64 s[42:43], vcc
    buffer_store_dword v44, v7, s[4:7], s40 offen
    s_mov_b64 exec, s[42:43]
L_conv_nofl:
    v_mov_b32 v44, 0
    v_mov_b32 v45, 0
    v_mov_b32 v46, 0
    v_mov_b32 v47, 0
    v_cmp_gt_u32 vcc, 160, v0
    v_add_u32 v7, 28672, v5
    v_add_u32 v7, s61, v7
    s_and_saveexec_b64 s[42:43], vcc
    ds_write_b128 v7, v[44:47]
    s_mov_b64 exec, s[42:43]
    v_lshrrev_b32 v7, 3, v0
    v_mul_u32_u24 v7, 4416, v7
    v_and_b32 v8, 7, v0
    v_lshlrev_b32 v8, 4, v8
    v_add_u32 v7, v7, v8
    v_add_u32 v7, 4096, v7
    v_add_u32 v7, s61, v7
    v_add_u32 v43, s61, v5
    v_cmp_gt_u32 vcc, 32, v0
    s_nop 1
    s_and_saveexec_b64 s[42:43], vcc
    ds_write_b128 v7, v[44:47]
    s_mov_b64 exec, s[42:43]
    s_waitcnt vmcnt(9)
    ds_write_b128 v43, v[24:27]
    v_alignbit_b32 v48, v25, v24, 16
    v_alignbit_b32 v49, v26, v25, 16
    v_alignbit_b32 v50, v27, v26, 16
    v_alignbit_b32 v51, v28, v27, 16
    ds_write_b128 v43, v[48:51] offset:4416
    v_mov_b32 v52, v25
    v_mov_b32 v53, v26
    v_mov_b32 v54, v27
    v_mov_b32 v55, v28
    ds_write_b128 v43, v[52:55] offset:8832
    v_alignbit_b32 v56, v26, v25, 16
    v_alignbit_b32 v57, v27, v26, 16
    v_alignbit_b32 v58, v28, v27, 16
    v_alignbit_b32 v59, v29, v28, 16
    ds_write_b128 v43, v[56:59] offset:13248
    s_waitcnt vmcnt(0)
    v_add_f32 v32, v32, v33
    v_add_f32 v32, v32, v34
    v_add_f32 v32, v32, v35
    v_add_f32 v32, v32, v36
    v_add_f32 v32, v32, v37
    v_add_f32 v32, v32, v38
    v_add_f32 v32, v32, v39
    v_add_f32 v32, v32, v40
    v_cvt_pk_bf16_f32 v32, v32, v32
    v_and_b32 v32, 0xffff0000, v32
    v_add_f32 v33, 1.0, v32
    v_cvt_pk_bf16_f32 v33, v33, v33
    v_and_b32 v33, 0xffff0000, v33
    v_cmp_eq_u32 vcc, 1, v1
    v_cmp_eq_u32 s[42:43], 4, v1
    s_nop 1
    s_or_b64 vcc, vcc, s[42:43]
    s_nop 1
    v_cndmask_b32 v32, v32, v33, vcc
    s_nop 1
    v_readlane_b32 s44, v32, 0
    v_readlane_b32 s45, v32, 1
    v_readlane_b32 s46, v32, 2
    s_cmp_eq_u32 s33, 0
    s_cbranch_scc0 L_conv_nomod
    v_sub_u32 v34, 8, v1
    v_cmp_gt_u32 vcc, 3, v1
    s_nop 1
    v_cndmask_b32 v34, v34, v1, vcc
    v_mul_u32_u24 v34, 2304, v34
    s_lshl_b32 s40, s2, 2
    s_add_u32 s40, s40, 7471104
    v_cmp_gt_u32 vcc, 6, v1
    s_nop 1
    s_and_saveexec_b64 s[42:43], vcc
    buffer_store_dword v32, v34, s[4:7], s40 offen
    s_mov_b64 exec, s[42:43]
L_conv_nomod:
    v_mov_b32 v38, s45
    v_mov_b32 v39, s44
    v_lshlrev_b32 v36, 16, v16
    v_and_b32 v37, 0xffff0000, v16
    v_fma_f32 v36, v36, v38, v39
    v_fma_f32 v37, v37, v38, v39
    v_cvt_pk_bf16_f32 v16, v36, v37
    v_lshlrev_b32 v36, 16, v17
    v_and_b32 v37, 0xffff0000, v17
    v_fma_f32 v36, v36, v38, v39
    v_fma_f32 v37, v37, v38, v39
    v_cvt_pk_bf16_f32 v17, v36, v37
    v_lshlrev_b32 v36, 16, v18
    v_and_b32 v37, 0xffff0000, v18
    v_fma_f32 v36, v36, v38, v39
    v_fma_f32 v37, v37, v38, v39
    v_cvt_pk_bf16_f32 v18, v36, v37
    v_lshlrev_b32 v36, 16, v19
    v_and_b32 v37, 0xffff0000, v19
    v_fma_f32 v36, v36, v38, v39
    v_fma_f32 v37, v37, v38, v39
    v_cvt_pk_bf16_f32 v19, v36, v37
    v_lshrrev_b32 v7, 3, v0
    v_mul_u32_u24 v7, 160, v7
    v_and_b32 v8, 7, v0
    v_lshlrev_b32 v8, 4, v8
    v_add_u32 v7, v7, v8
    v_add_u32 v7, s61, v7
    ds_write_b128 v7, v[16:19] offset:31232
    v_mov_b32 v29, v7
    v_sub_u32 v10, 3, v3
    v_and_b32 v10, 3, v10
    v_mul_u32_u24 v11, 4416, v10
    v_lshlrev_b32 v12, 3, v4
    v_sub_u32 v12, v12, v3
    v_sub_u32 v12, v12, v10
    v_add_u32 v12, 2047, v12
    v_lshlrev_b32 v12, 1, v12
    v_add_u32 v14, v11, v12
    v_add_u32 v14, s61, v14
    v_mul_u32_u24 v11, 160, v3
    v_lshlrev_b32 v12, 4, v4
    v_add_u32 v11, v11, v12
    v_add_u32 v15, 31232, v11
    v_add_u32 v15, s61, v15
    s_mul_i32 s48, s33, 6
    s_mov_b32 s49, 3
    s_mov_b32 s50, 16
    s_mov_b32 s51, 0
    s_cmp_eq_u32 s33, 2
    s_cselect_b32 s49, 2, s49
    s_cselect_b32 s51, 2, s51
    s_cmp_eq_u32 s33, 3
    s_cselect_b32 s49, 0, s49
    s_cselect_b32 s50, 20, s50
    s_cselect_b32 s51, 6, s51
    s_cmp_eq_u32 s63, 0
    s_cbranch_scc0 L_conv_segs
    s_mov_b32 s49, 0
    s_add_u32 s51, s62, 1
    s_lshl_b32 s51, s51, 1
    s_lshl_b32 s50, s51, 1
    s_mul_i32 s50, s50, s33
L_conv_segs:
    s_mul_i32 s60, s62, 2560
    v_mov_b32 v64, 0
    v_mov_b32 v65, 0
    v_mov_b32 v66, 0
    v_mov_b32 v67, 0
    v_mov_b32 v68, 0
    v_mov_b32 v69, 0
    v_mov_b32 v70, 0
    v_mov_b32 v71, 0
    v_mov_b32 v72, 0
    v_mov_b32 v73, 0
    v_mov_b32 v74, 0
    v_mov_b32 v75, 0
    v_mov_b32 v76, 0
    v_mov_b32 v77, 0
    v_mov_b32 v78, 0
    v_mov_b32 v79, 0
    v_mov_b32 v80, 0
    v_mov_b32 v81, 0
    v_mov_b32 v82, 0
    v_mov_b32 v83, 0
    v_mov_b32 v84, 0
    v_mov_b32 v85, 0
    v_mov_b32 v86, 0
    v_mov_b32 v87, 0
    v_mov_b32 v88, 0
    v_mov_b32 v89, 0
    v_mov_b32 v90, 0
    v_mov_b32 v91, 0
    v_mov_b32 v92, 0
    v_mov_b32 v93, 0
    v_mov_b32 v94, 0
    v_mov_b32 v95, 0
    s_waitcnt vmcnt(0) lgkmcnt(0)
    s_barrier
    buffer_load_dwordx4 v[20:23], v30, s[4:7], s36 offen
    s_mov_b32 s58, 5308416
    s_mov_b32 s59, 0x20000
    s_cmp_lt_u32 s55, 128
    s_cselect_b32 s54, 0, 128
    s_sub_u32 s54, s55, s54
    s_mul_i32 s54, s54, 41472
    v_lshlrev_b32 v10, 7, v42
    v_add_u32 v10, s54, v10
    v_cmp_gt_u32 vcc, 324, v42
    s_nop 1
    v_cndmask_b32 v10, -16, v10, vcc
    buffer_load_dword v31, v10, s[56:59], 0 offen
    s_cmp_eq_u32 s55, 8
    s_cbranch_scc0 L_conv_nob
    s_mov_b32 s10, 9216
    s_mov_b32 s11, 0x20000
    s_mov_b32 s14, 1152
    s_mov_b32 s15, 0x20000
    v_lshlrev_b32 v10, 7, v42
    buffer_load_dword v31, v10, s[8:11], 0 offen
    buffer_load_dword v31, v10, s[12:15], 0 offen
L_conv_nob:
    s_cmp_eq_u32 s49, 0
    s_cbranch_scc1 L_segA_skip
    s_lshl_b32 s52, s48, 7
    s_add_u32 s52, s52, 96
    v_subrev_u32 v8, s52, v14
    s_mul_i32 s52, s48, 160
    s_sub_u32 s52, 0, s52
    v_add_u32 v9, s52, v15
    ds_read_b64 v[120:121], v8 offset:160
    ds_read_b64 v[122:123], v8 offset:168
    ds_read_b64 v[124:125], v8 offset:128
    ds_read_b64 v[126:127], v8 offset:136
    ds_read_b64 v[96:97], v8 offset:96
    ds_read_b64 v[98:99], v8 offset:104
    ds_read_b64 v[100:101], v8 offset:64
    ds_read_b64 v[102:103], v8 offset:72
    ds_read_b64 v[104:105], v8 offset:32
    ds_read_b64 v[106:107], v8 offset:40
    ds_read_b64 v[108:109], v8 offset:0
    ds_read_b64 v[110:111], v8 offset:8
    ds_read_b128 v[32:35], v9 offset:0
    ds_read_b128 v[36:39], v9 offset:64
    ds_read_b128 v[40:43], v9 offset:2560
    ds_read_b128 v[44:47], v9 offset:2624
    s_waitcnt lgkmcnt(0)
L_segA_loop:
    s_waitcnt lgkmcnt(4)
    v_mfma_f32_16x16x32_bf16 v[64:67], v[120:123], v[36:39], v[64:67]
    v_subrev_u32 v8, 128, v8
    v_subrev_u32 v9, 160, v9
    v_mfma_f32_16x16x32_bf16 v[80:83], v[120:123], v[44:47], v[80:83]
    ds_read_b128 v[48:51], v9 offset:0
    v_mfma_f32_16x16x32_bf16 v[68:71], v[124:127], v[36:39], v[68:71]
    ds_read_b128 v[52:55], v9 offset:64
    v_mfma_f32_16x16x32_bf16 v[84:87], v[124:127], v[44:47], v[84:87]
    ds_read_b128 v[56:59], v9 offset:2560
    v_mfma_f32_16x16x32_bf16 v[72:75], v[96:99], v[36:39], v[72:75]
    ds_read_b128 v[60:63], v9 offset:2624
    v_mfma_f32_16x16x32_bf16 v[88:91], v[96:99], v[44:47], v[88:91]
    ds_read_b64 v[112:113], v8 offset:96
    ds_read_b64 v[114:115], v8 offset:104
    v_mfma_f32_16x16x32_bf16 v[76:79], v[100:103], v[36:39], v[76:79]
    v_mfma_f32_16x16x32_bf16 v[92:95], v[100:103], v[44:47], v[92:95]
    ds_read_b64 v[116:117], v8 offset:64
    ds_read_b64 v[118:119], v8 offset:72
    v_mfma_f32_16x16x32_bf16 v[64:67], v[96:99], v[32:35], v[64:67]
    v_mfma_f32_16x16x32_bf16 v[80:83], v[96:99], v[40:43], v[80:83]
    ds_read_b64 v[120:121], v8 offset:32
    ds_read_b64 v[122:123], v8 offset:40
    v_mfma_f32_16x16x32_bf16 v[68:71], v[100:103], v[32:35], v[68:71]
    v_mfma_f32_16x16x32_bf16 v[84:87], v[100:103], v[40:43], v[84:87]
    s_waitcnt lgkmcnt(10)
    v_mfma_f32_16x16x32_bf16 v[72:75], v[104:107], v[32:35], v[72:75]
    ds_read_b64 v[124:125], v8 offset:0
    ds_read_b64 v[126:127], v8 offset:8
    v_mfma_f32_16x16x32_bf16 v[88:91], v[104:107], v[40:43], v[88:91]
    v_mfma_f32_16x16x32_bf16 v[76:79], v[108:111], v[32:35], v[76:79]
    v_mfma_f32_16x16x32_bf16 v[92:95], v[108:111], v[40:43], v[92:95]
    s_waitcnt lgkmcnt(4)
    v_mfma_f32_16x16x32_bf16 v[64:67], v[104:107], v[52:55], v[64:67]
    v_subrev_u32 v8, 128, v8
    v_subrev_u32 v9, 160, v9
    v_mfma_f32_16x16x32_bf16 v[80:83], v[104:107], v[60:63], v[80:83]
    ds_read_b128 v[32:35], v9 offset:0
    v_mfma_f32_16x16x32_bf16 v[68:71], v[108:111], v[52:55], v[68:71]
    ds_read_b128 v[36:39], v9 offset:64
    v_mfma_f32_16x16x32_bf16 v[84:87], v[108:111], v[60:63], v[84:87]
    ds_read_b128 v[40:43], v9 offset:2560
    v_mfma_f32_16x16x32_bf16 v[72:75], v[112:115], v[52:55], v[72:75]
    ds_read_b128 v[44:47], v9 offset:2624
    v_mfma_f32_16x16x32_bf16 v[88:91], v[112:115], v[60:63], v[88:91]
    ds_read_b64 v[96:97], v8 offset:96
    ds_read_b64 v[98:99], v8 offset:104
    v_mfma_f32_16x16x32_bf16 v[76:79], v[116:119], v[52:55], v[76:79]
    v_mfma_f32_16x16x32_bf16 v[92:95], v[116:119], v[60:63], v[92:95]
    ds_read_b64 v[100:101], v8 offset:64
    ds_read_b64 v[102:103], v8 offset:72
    v_mfma_f32_16x16x32_bf16 v[64:67], v[112:115], v[48:51], v[64:67]
    v_mfma_f32_16x16x32_bf16 v[80:83], v[112:115], v[56:59], v[80:83]
    ds_read_b64 v[104:105], v8 offset:32
    ds_read_b64 v[106:107], v8 offset:40
    v_mfma_f32_16x16x32_bf16 v[68:71], v[116:119], v[48:51], v[68:71]
    v_mfma_f32_16x16x32_bf16 v[84:87], v[116:119], v[56:59], v[84:87]
    s_waitcnt lgkmcnt(10)
    v_mfma_f32_16x16x32_bf16 v[72:75], v[120:123], v[48:51], v[72:75]
    ds_read_b64 v[108:109], v8 offset:0
    ds_read_b64 v[110:111], v8 offset:8
    v_mfma_f32_16x16x32_bf16 v[88:91], v[120:123], v[56:59], v[88:91]
    v_mfma_f32_16x16x32_bf16 v[76:79], v[124:127], v[48:51], v[76:79]
    v_mfma_f32_16x16x32_bf16 v[92:95], v[124:127], v[56:59], v[92:95]
    s_sub_u32 s49, s49, 1
    s_cmp_lg_u32 s49, 0
    s_cbranch_scc1 L_segA_loop
    s_waitcnt lgkmcnt(0)
L_segA_skip:
    s_cmp_eq_u32 s51, 0
    s_cbranch_scc1 L_segB_skip
    s_lshl_b32 s52, s50, 7
    s_add_u32 s52, s52, 96
    v_subrev_u32 v8, s52, v14
    s_mul_i32 s52, s50, 160
    s_sub_u32 s52, s60, s52
    v_add_u32 v9, s52, v15
    ds_read_b64 v[120:121], v8 offset:160
    ds_read_b64 v[122:123], v8 offset:168
    ds_read_b64 v[124:125], v8 offset:128
    ds_read_b64 v[126:127], v8 offset:136
    ds_read_b64 v[96:97], v8 offset:96
    ds_read_b64 v[98:99], v8 offset:104
    ds_read_b64 v[100:101], v8 offset:64
    ds_read_b64 v[102:103], v8 offset:72
    ds_read_b64 v[104:105], v8 offset:32
    ds_read_b64 v[106:107], v8 offset:40
    ds_read_b64 v[108:109], v8 offset:0
    ds_read_b64 v[110:111], v8 offset:8
    ds_read_b128 v[40:43], v9 offset:0
    ds_read_b128 v[44:47], v9 offset:64
    s_waitcnt lgkmcnt(0)
L_segB_loop:
    s_waitcnt lgkmcnt(4)
    v_mfma_f32_16x16x32_bf16 v[80:83], v[120:123], v[44:47], v[80:83]
    v_subrev_u32 v8, 128, v8
    v_subrev_u32 v9, 160, v9
    v_mfma_f32_16x16x32_bf16 v[84:87], v[124:127], v[44:47], v[84:87]
    ds_read_b128 v[56:59], v9 offset:0
    v_mfma_f32_16x16x32_bf16 v[88:91], v[96:99], v[44:47], v[88:91]
    ds_read_b128 v[60:63], v9 offset:64
    v_mfma_f32_16x16x32_bf16 v[92:95], v[100:103], v[44:47], v[92:95]
    ds_read_b64 v[112:113], v8 offset:96
    ds_read_b64 v[114:115], v8 offset:104
    v_mfma_f32_16x16x32_bf16 v[80:83], v[96:99], v[40:43], v[80:83]
    ds_read_b64 v[116:117], v8 offset:64
    ds_read_b64 v[118:119], v8 offset:72
    v_mfma_f32_16x16x32_bf16 v[84:87], v[100:103], v[40:43], v[84:87]
    ds_read_b64 v[120:121], v8 offset:32
    ds_read_b64 v[122:123], v8 offset:40
    s_waitcnt lgkmcnt(8)
    v_mfma_f32_16x16x32_bf16 v[88:91], v[104:107], v[40:43], v[88:91]
    ds_read_b64 v[124:125], v8 offset:0
    ds_read_b64 v[126:127], v8 offset:8
    v_mfma_f32_16x16x32_bf16 v[92:95], v[108:111], v[40:43], v[92:95]
    s_waitcnt lgkmcnt(4)
    v_mfma_f32_16x16x32_bf16 v[80:83], v[104:107], v[60:63], v[80:83]
    v_subrev_u32 v8, 128, v8
    v_subrev_u32 v9, 160, v9
    v_mfma_f32_16x16x32_bf16 v[84:87], v[108:111], v[60:63], v[84:87]
    ds_read_b128 v[40:43], v9 offset:0
    v_mfma_f32_16x16x32_bf16 v[88:91], v[112:115], v[60:63], v[88:91]
    ds_read_b128 v[44:47], v9 offset:64
    v_mfma_f32_16x16x32_bf16 v[92:95], v[116:119], v[60:63], v[92:95]
    ds_read_b64 v[96:97], v8 offset:96
    ds_read_b64 v[98:99], v8 offset:104
    v_mfma_f32_16x16x32_bf16 v[80:83], v[112:115], v[56:59], v[80:83]
    ds_read_b64 v[100:101], v8 offset:64
    ds_read_b64 v[102:103], v8 offset:72
    v_mfma_f32_16x16x32_bf16 v[84:87], v[116:119], v[56:59], v[84:87]
    ds_read_b64 v[104:105], v8 offset:32
    ds_read_b64 v[106:107], v8 offset:40
    s_waitcnt lgkmcnt(8)
    v_mfma_f32_16x16x32_bf16 v[88:91], v[120:123], v[56:59], v[88:91]
    ds_read_b64 v[108:109], v8 offset:0
    ds_read_b64 v[110:111], v8 offset:8
    v_mfma_f32_16x16x32_bf16 v[92:95], v[124:127], v[56:59], v[92:95]
    s_sub_u32 s51, s51, 1
    s_cmp_lg_u32 s51, 0
    s_cbranch_scc1 L_segB_loop
    s_waitcnt lgkmcnt(0)
L_segB_skip:
    s_waitcnt vmcnt(1)
    ds_write_b128 v29, v[20:23] offset:36352
    s_barrier
    v_lshlrev_b32 v10, 4, v1
    v_add_u32 v10, s61, v10
    s_lshl_b32 s52, s33, 12
    v_add_u32 v11, s52, v10
    s_cmp_eq_u32 s63, 0
    s_cbranch_scc1 L_conv_noA
    s_cmp_lt_u32 s33, 3
    s_cbranch_scc0 L_conv_noA
    s_nop 4
    ds_write_b128 v11, v[64:67] offset:0
    ds_write_b128 v11, v[68:71] offset:1024
    ds_write_b128 v11, v[72:75] offset:2048
    ds_write_b128 v11, v[76:79] offset:3072
L_conv_noA:
    s_nop 4
    ds_write_b128 v11, v[80:83] offset:12288
    ds_write_b128 v11, v[84:87] offset:13312
    ds_write_b128 v11, v[88:91] offset:14336
    ds_write_b128 v11, v[92:95] offset:15360
    s_waitcnt lgkmcnt(0)
    s_barrier
    s_lshl_b32 s52, s33, 10
    v_add_u32 v11, s52, v10
    ds_read_b128 v[64:67], v11 offset:0
    ds_read_b128 v[68:71], v11 offset:4096
    ds_read_b128 v[72:75], v11 offset:8192
    ds_read_b128 v[76:79], v11 offset:12288
    ds_read_b128 v[80:83], v11 offset:16384
    ds_read_b128 v[84:87], v11 offset:20480
    ds_read_b128 v[88:91], v11 offset:24576
    v_mul_u32_u24 v12, 160, v3
    v_lshlrev_b32 v13, 3, v4
    v_add_u32 v12, v12, v13
    s_lshl_b32 s52, s33, 5
    s_add_u32 s52, s52, s61
    v_add_u32 v12, s52, v12
    v_add_u32 v11, s60, v12
    ds_read_b64 v[96:97], v12 offset:31232
    ds_read_b64 v[98:99], v11 offset:31232
    ds_read_b64 v[100:101], v12 offset:36352
    ds_read_b64 v[102:103], v11 offset:36352
    s_bitcmp1_b32 s2, 0
    s_cselect_b32 s53, 0, 16
    s_lshl_b32 s35, s35, s53
    s_and_b32 s35, s35, 0xffff0000
    v_mov_b32 v22, s35
    v_mov_b32 v23, s46
    v_mul_u32_u24 v13, 73728, v3
    v_lshlrev_b32 v12, 3, v4
    v_add_u32 v13, v13, v12
    s_lshl_b32 s52, s33, 5
    v_add_u32 v13, s52, v13
    s_lshl_b32 s52, s2, 7
    s_add_u32 s52, s52, 7602176
    s_mul_i32 s53, s62, 1179648
    s_add_u32 s53, s53, s52
    s_waitcnt lgkmcnt(0)
    v_add_f32 v64, v64, v68
    v_add_f32 v76, v76, v80
    v_add_f32 v84, v84, v88
    v_add_f32 v65, v65, v69
    v_add_f32 v77, v77, v81
    v_add_f32 v85, v85, v89
    v_add_f32 v66, v66, v70
    v_add_f32 v78, v78, v82
    v_add_f32 v86, v86, v90
    v_add_f32 v67, v67, v71
    v_add_f32 v79, v79, v83
    v_add_f32 v87, v87, v91
    v_add_f32 v64, v64, v72
    v_add_f32 v76, v76, v84
    v_add_f32 v65, v65, v73
    v_add_f32 v77, v77, v85
    v_add_f32 v66, v66, v74
    v_add_f32 v78, v78, v86
    v_add_f32 v67, v67, v75
    v_add_f32 v79, v79, v87
    s_cmp_eq_u32 s63, 0
    s_cbranch_scc1 L_conv_noj0
    v_lshlrev_b32 v17, 16, v96
    v_and_b32 v18, 0xffff0000, v96
    v_lshlrev_b32 v20, 16, v100
    v_and_b32 v21, 0xffff0000, v100
    v_fma_f32 v17, v17, v22, v64
    v_fma_f32 v18, v18, v22, v65
    v_fma_f32 v17, v17, v23, v20
    v_fma_f32 v18, v18, v23, v21
    v_cvt_pk_bf16_f32 v24, v17, v18
    v_lshlrev_b32 v17, 16, v97
    v_and_b32 v18, 0xffff0000, v97
    v_lshlrev_b32 v20, 16, v101
    v_and_b32 v21, 0xffff0000, v101
    v_fma_f32 v17, v17, v22, v66
    v_fma_f32 v18, v18, v22, v67
    v_fma_f32 v17, v17, v23, v20
    v_fma_f32 v18, v18, v23, v21
    v_cvt_pk_bf16_f32 v25, v17, v18
    buffer_store_dwordx2 v[24:25], v13, s[4:7], s52 offen
L_conv_noj0:
    v_lshlrev_b32 v17, 16, v98
    v_and_b32 v18, 0xffff0000, v98
    v_lshlrev_b32 v20, 16, v102
    v_and_b32 v21, 0xffff0000, v102
    v_fma_f32 v17, v17, v22, v76
    v_fma_f32 v18, v18, v22, v77
    v_fma_f32 v17, v17, v23, v20
    v_fma_f32 v18, v18, v23, v21
    v_cvt_pk_bf16_f32 v26, v17, v18
    v_lshlrev_b32 v17, 16, v99
    v_and_b32 v18, 0xffff0000, v99
    v_lshlrev_b32 v20, 16, v103
    v_and_b32 v21, 0xffff0000, v103
    v_fma_f32 v17, v17, v22, v78
    v_fma_f32 v18, v18, v22, v79
    v_fma_f32 v17, v17, v23, v20
    v_fma_f32 v18, v18, v23, v21
    v_cvt_pk_bf16_f32 v27, v17, v18
    buffer_store_dwordx2 v[26:27], v13, s[4:7], s53 offen
    s_waitcnt vmcnt(0)
L_conv_end:
    s_endpgm
.section .rodata,"a"
.p2align 6
L_kd_conv_kernel:
.amdhsa_kernel conv_kernel
  .amdhsa_next_free_vgpr 128
  .amdhsa_next_free_sgpr 96
  .amdhsa_accum_offset 128
  .amdhsa_group_segment_fixed_size 0
  .amdhsa_kernarg_size 136
  .amdhsa_user_sgpr_count 2
  .amdhsa_user_sgpr_kernarg_segment_ptr 1
  .amdhsa_system_sgpr_workgroup_id_x 1
  .amdhsa_float_denorm_mode_32 3
.end_amdhsa_kernel

.text
.globl mlp_kernel
.p2align 8
.type mlp_kernel,@function
mlp_kernel:
    s_cmp_ge_u32 s2, 256
    s_cbranch_scc1 L_mlp_end
    s_load_dwordx2 s[20:21], s[0:1], 64
    s_load_dwordx2 s[22:23], s[0:1], 72
    s_load_dwordx2 s[24:25], s[0:1], 80
    s_load_dwordx2 s[26:27], s[0:1], 128
    v_and_b32 v1, 63, v0
    v_lshrrev_b32 v2, 6, v0
    s_and_b32 s46, s2, 7
    s_lshr_b32 s47, s2, 3
    s_and_b32 s35, s46, 1
    s_lshl_b32 s35, s35, 2
    s_and_b32 s48, s47, 3
    s_add_u32 s35, s35, s48
    s_lshr_b32 s34, s46, 1
    s_mul_i32 s34, s34, 8
    s_lshr_b32 s48, s47, 2
    s_add_u32 s34, s34, s48
    v_readfirstlane_b32 s33, v2
    v_and_b32 v14, 15, v1
    v_lshrrev_b32 v15, 4, v1
    v_lshrrev_b32 v16, 3, v1
    v_and_b32 v17, 7, v1
    v_and_b32 v18, 2, v16
    s_and_b32 s46, s33, 1
    s_lshl_b32 s46, s46, 2
    v_or_b32 v18, s46, v18
    v_xor_b32 v17, v17, v18
    v_lshlrev_b32 v17, 4, v17
    s_lshl_b32 s47, s33, 3
    v_add_u32 v16, s47, v16
    v_lshlrev_b32 v19, 7, v16
    v_add_u32 v2, v19, v17
    v_mul_u32_u24 v19, 9216, v16
    v_add_u32 v3, v19, v17
    v_mul_u32_u24 v19, 1152, v16
    v_add_u32 v4, v19, v17
    s_lshl_b32 s41, s33, 10
    s_waitcnt lgkmcnt(0)
    s_mov_b32 s4, s26
    s_mov_b32 s5, s27
    s_mov_b32 s6, 268435456
    s_mov_b32 s7, 0x20000
    s_mov_b32 s8, s20
    s_mov_b32 s9, s21
    s_mov_b32 s10, 5308416
    s_mov_b32 s11, 0x20000
    s_mov_b32 s12, s24
    s_mov_b32 s13, s25
    s_mov_b32 s14, 5308416
    s_mov_b32 s15, 0x20000
    s_mov_b32 s16, s20
    s_mov_b32 s17, s21
    s_mov_b32 s18, 5308416
    s_mov_b32 s19, 0x20000
    s_mov_b32 s28, s22
    s_mov_b32 s29, s23
    s_mov_b32 s30, 9216
    s_mov_b32 s31, 0x20000
    s_mul_i32 s46, s34, 73728
    s_add_u32 s46, s46, 7602176
    s_add_u32 m0, s41, 0
    s_add_u32 s47, s46, 0
    buffer_load_dwordx4 v2, s[4:7], s47 offen  lds
    s_add_u32 m0, s41, 8192
    s_add_u32 s47, s46, 8192
    buffer_load_dwordx4 v2, s[4:7], s47 offen  lds
    s_add_u32 m0, s41, 16384
    s_add_u32 s47, s46, 16384
    buffer_load_dwordx4 v2, s[4:7], s47 offen  lds
    s_add_u32 m0, s41, 24576
    s_add_u32 s47, s46, 24576
    buffer_load_dwordx4 v2, s[4:7], s47 offen  lds
    s_add_u32 m0, s41, 32768
    s_add_u32 s47, s46, 32768
    buffer_load_dwordx4 v2, s[4:7], s47 offen  lds
    s_add_u32 m0, s41, 40960
    s_add_u32 s47, s46, 40960
    buffer_load_dwordx4 v2, s[4:7], s47 offen  lds
    s_add_u32 m0, s41, 49152
    s_add_u32 s47, s46, 49152
    buffer_load_dwordx4 v2, s[4:7], s47 offen  lds
    s_add_u32 m0, s41, 57344
    s_add_u32 s47, s46, 57344
    buffer_load_dwordx4 v2, s[4:7], s47 offen  lds
    s_add_u32 m0, s41, 65536
    s_add_u32 s47, s46, 65536
    buffer_load_dwordx4 v2, s[4:7], s47 offen  lds
    s_cmp_lt_u32 s2, 8
    s_cbranch_scc0 L_mlp_nocpf
    s_getpc_b64 s[50:51]
L_mlp_pc:
    s_sub_u32 s50, s50, L_mlp_pc - mlp_kernel
    s_subb_u32 s51, s51, 0
    v_lshlrev_b32 v24, 7, v0
    v_cmp_gt_u32 vcc, L_mlp_end - mlp_kernel, v24
    v_mov_b32 v27, s51
    v_add_co_u32 v26, s[52:53], s50, v24
    s_nop 1
    v_addc_co_u32 v27, s[52:53], 0, v27, s[52:53]
    s_and_saveexec_b64 s[54:55], vcc
    global_load_dword v74, v[26:27], off
    s_mov_b64 exec, s[54:55]
L_mlp_nocpf:
    v_lshlrev_b32 v16, 4, v0
    s_mov_b32 s46, 7480320
    buffer_load_dwordx4 v[24:27], v16, s[4:7], s46 offen
    v_subrev_u32 v17, 288, v0
    v_lshlrev_b32 v17, 3, v17
    s_mul_i32 s46, s35, 1152
    v_cmp_gt_u32 vcc, 288, v0
    v_add_u32 v17, s46, v17
    s_nop 0
    v_cndmask_b32 v17, v17, -16, vcc
    buffer_load_dwordx2 v[28:29], v17, s[28:31], 0 offen
    s_mul_i32 s37, s35, 1152
    s_mov_b32 s38, 1769472
    s_mov_b32 s39, 4291428480
    s_mov_b32 s40, 589824
    s_mov_b32 s63, 0
    s_mov_b32 s60, 0
    s_mov_b32 s61, 15
    s_mov_b32 s62, s37
    v_add_u32 v22, 589824, v3
    v_add_u32 v23, 1179648, v3
    v_lshrrev_b32 v16, 2, v14
    v_and_b32 v17, 3, v1
    v_lshlrev_b32 v18, 3, v15
    v_add_u32 v18, v18, v16
    v_lshlrev_b32 v18, 7, v18
    v_and_b32 v19, 2, v16
    v_and_b32 v20, 1, v15
    v_lshlrev_b32 v20, 2, v20
    v_or_b32 v19, v19, v20
    s_and_b32 s46, s33, 3
    s_lshl_b32 s46, s46, 1
    v_lshrrev_b32 v20, 1, v17
    v_add_u32 v20, s46, v20
    v_xor_b32 v20, v20, v19
    v_lshlrev_b32 v20, 4, v20
    v_and_b32 v17, 1, v17
    v_lshlrev_b32 v17, 3, v17
    v_add_u32 v18, v18, v20
    v_add_u32 v5, v18, v17
    v_add_u32 v6, 49152, v5
    v_add_u32 v7, 98304, v5
    s_waitcnt vmcnt(0)
    v_lshlrev_b32 v32, 16, v28
    v_and_b32 v33, 0xffff0000, v28
    v_lshlrev_b32 v34, 16, v29
    v_and_b32 v35, 0xffff0000, v29
    v_cmp_gt_u32 vcc, 288, v0
    s_nop 1
    v_cndmask_b32 v24, v32, v24, vcc
    v_cndmask_b32 v25, v33, v25, vcc
    v_cndmask_b32 v26, v34, v26, vcc
    v_cndmask_b32 v27, v35, v27, vcc
    v_lshlrev_b32 v16, 4, v0
    v_add_u32 v16, 147456, v16
    v_cmp_gt_u32 vcc, 432, v0
    s_nop 1
    s_and_saveexec_b64 s[50:51], vcc
    ds_write_b128 v16, v[24:27]
    s_mov_b64 exec, s[50:51]
    v_mov_b32 v10, 0xc0135761
    s_and_b32 s46, s33, 3
    s_lshr_b32 s47, s33, 2
    s_lshl_b32 s48, s46, 6
    s_add_u32 s48, s48, 152064
    v_lshlrev_b32 v8, 4, v15
    v_add_u32 v8, s48, v8
    s_mul_i32 s48, s47, 36864
    v_lshlrev_b32 v12, 4, v1
    v_add_u32 v12, s48, v12
    s_lshr_b32 s48, s46, 1
    s_lshl_b32 s48, s48, 10
    s_mul_i32 s49, s47, 36864
    s_add_u32 s48, s48, s49
    s_and_b32 s49, s46, 1
    s_lshl_b32 s49, s49, 9
    s_add_u32 s48, s48, s49
    s_add_u32 s48, s48, 73728
    v_lshrrev_b32 v16, 1, v15
    v_lshlrev_b32 v16, 8, v16
    v_lshlrev_b32 v17, 4, v14
    v_add_u32 v16, v16, v17
    v_and_b32 v17, 1, v15
    v_lshlrev_b32 v17, 3, v17
    v_add_u32 v16, v16, v17
    v_add_u32 v13, s48, v16
    v_lshlrev_b32 v9, 4, v1
    v_add_u32 v9, s41, v9
    s_lshl_b32 s48, s34, 3
    s_add_u32 s48, s48, s35
    s_mul_i32 s44, s48, 73728
    s_add_u32 s44, s44, 12582912
    s_mov_b32 s43, 0x7ff00000
    v_mov_b32 v44, 0x3f803f80
    v_mov_b32 v45, 0x3f803f80
    v_mov_b32 v46, 0x3f803f80
    v_mov_b32 v47, 0x3f803f80
    s_mul_i32 s48, s47, 36864
    v_add_u32 v16, s48, v5
    v_and_b32 v17, 3, v14
    v_cmp_eq_u32 s[52:53], 1, v17
    v_cmp_eq_u32 s[54:55], 2, v17
    v_cmp_eq_u32 s[56:57], 3, v17
    v_lshrrev_b32 v17, 2, v14
    v_cmp_eq_u32 s[58:59], v17, v15
    s_lshl_b32 s48, s46, 8
    v_lshlrev_b32 v18, 4, v14
    v_add_u32 v18, s48, v18
    v_add_u32 v18, 154368, v18
    s_lshl_b32 s48, s47, 3
    v_add_u32 v19, s48, v18
    s_waitcnt lgkmcnt(0)
    s_barrier
    ds_read_b64_tr_b16 v[112:113], v16 offset:0
    ds_read_b64_tr_b16 v[114:115], v16 offset:512
    ds_read_b64_tr_b16 v[116:117], v16 offset:4096
    ds_read_b64_tr_b16 v[118:119], v16 offset:4608
    ds_read_b64_tr_b16 v[120:121], v16 offset:8192
    ds_read_b64_tr_b16 v[122:123], v16 offset:8704
    ds_read_b64_tr_b16 v[124:125], v16 offset:12288
    ds_read_b64_tr_b16 v[126:127], v16 offset:12800
    ds_read_b64_tr_b16 v[128:129], v16 offset:16384
    ds_read_b64_tr_b16 v[130:131], v16 offset:16896
    ds_read_b64_tr_b16 v[132:133], v16 offset:20480
    ds_read_b64_tr_b16 v[134:135], v16 offset:20992
    ds_read_b64_tr_b16 v[136:137], v16 offset:24576
    ds_read_b64_tr_b16 v[138:139], v16 offset:25088
    ds_read_b64_tr_b16 v[140:141], v16 offset:28672
    ds_read_b64_tr_b16 v[142:143], v16 offset:29184
    ds_read_b64_tr_b16 v[144:145], v16 offset:32768
    ds_read_b64_tr_b16 v[146:147], v16 offset:33280
    s_waitcnt lgkmcnt(15)
    v_mfma_f32_16x16x32_bf16 v[56:59], v[44:47], v[112:115], 0
    v_mfma_f32_16x16x32_bf16 v[60:63], v[112:115], v[112:115], 0
    s_waitcnt lgkmcnt(14)
    v_mfma_f32_16x16x32_bf16 v[56:59], v[44:47], v[116:119], v[56:59]
    v_mfma_f32_16x16x32_bf16 v[60:63], v[116:119], v[116:119], v[60:63]
    s_waitcnt lgkmcnt(12)
    v_mfma_f32_16x16x32_bf16 v[56:59], v[44:47], v[120:123], v[56:59]
    v_mfma_f32_16x16x32_bf16 v[60:63], v[120:123], v[120:123], v[60:63]
    s_waitcnt lgkmcnt(10)
    v_mfma_f32_16x16x32_bf16 v[56:59], v[44:47], v[124:127], v[56:59]
    v_mfma_f32_16x16x32_bf16 v[60:63], v[124:127], v[124:127], v[60:63]
    s_waitcnt lgkmcnt(8)
    v_mfma_f32_16x16x32_bf16 v[56:59], v[44:47], v[128:131], v[56:59]
    v_mfma_f32_16x16x32_bf16 v[60:63], v[128:131], v[128:131], v[60:63]
    s_waitcnt lgkmcnt(6)
    v_mfma_f32_16x16x32_bf16 v[56:59], v[44:47], v[132:135], v[56:59]
    v_mfma_f32_16x16x32_bf16 v[60:63], v[132:135], v[132:135], v[60:63]
    s_waitcnt lgkmcnt(4)
    v_mfma_f32_16x16x32_bf16 v[56:59], v[44:47], v[136:139], v[56:59]
    v_mfma_f32_16x16x32_bf16 v[60:63], v[136:139], v[136:139], v[60:63]
    s_waitcnt lgkmcnt(2)
    v_mfma_f32_16x16x32_bf16 v[56:59], v[44:47], v[140:143], v[56:59]
    v_mfma_f32_16x16x32_bf16 v[60:63], v[140:143], v[140:143], v[60:63]
    s_waitcnt lgkmcnt(0)
    v_mfma_f32_16x16x32_bf16 v[56:59], v[44:47], v[144:147], v[56:59]
    v_mfma_f32_16x16x32_bf16 v[60:63], v[144:147], v[144:147], v[60:63]
    s_nop 7
    v_cndmask_b32 v24, v60, v61, s[52:53]
    v_cndmask_b32 v24, v24, v62, s[54:55]
    v_cndmask_b32 v25, v24, v63, s[56:57]
    v_mov_b32 v24, v56
    s_mov_b64 s[50:51], exec
    s_mov_b64 exec, s[58:59]
    ds_write_b64 v19, v[24:25] offset:0
    s_mov_b64 exec, s[50:51]
    s_waitcnt lgkmcnt(0)
    s_barrier
    ds_read_b128 v[28:31], v18 offset:0
    s_mul_i32 s48, s47, 1152
    s_add_u32 s48, s48, 147456
    v_lshlrev_b32 v20, 5, v15
    v_add_u32 v20, s48, v20
    ds_read_b128 v[220:223], v20 offset:0
    ds_read_b128 v[224:227], v20 offset:16
    ds_read_b128 v[228:231], v20 offset:2304
    ds_read_b128 v[232:235], v20 offset:2320
    s_waitcnt lgkmcnt(4)
    v_add_f32 v24, v28, v30
    v_add_f32 v25, v29, v31
    v_mul_f32 v24, 0x3ae38e39, v24
    v_mul_f32 v25, 0x3ae38e39, v25
    v_fma_f32 v25, -v24, v24, v25
    v_max_f32 v25, 0, v25
    v_add_f32 v25, 0x3727c5ac, v25
    v_rsq_f32 v26, v25
    s_nop 0
    v_mul_f32 v27, v24, v26
    v_sub_f32 v27, 0, v27
    ds_read_b128 v[236:239], v20 offset:128
    ds_read_b128 v[240:243], v20 offset:144
    ds_read_b128 v[244:247], v20 offset:2432
    ds_read_b128 v[248:251], v20 offset:2448
    s_add_u32 m0, s41, 73728
    s_nop 0
    buffer_load_dwordx4 v3, s[16:19], s37 offen  lds
    v_lshlrev_b32 v148, 16, v112
    v_and_b32 v149, 0xffff0000, v112
    v_lshlrev_b32 v150, 16, v113
    v_and_b32 v151, 0xffff0000, v113
    v_lshlrev_b32 v152, 16, v114
    v_and_b32 v153, 0xffff0000, v114
    v_lshlrev_b32 v154, 16, v115
    v_and_b32 v155, 0xffff0000, v115
    v_fma_f32 v148, v148, v26, v27
    v_fma_f32 v149, v149, v26, v27
    v_fma_f32 v150, v150, v26, v27
    v_fma_f32 v151, v151, v26, v27
    v_fma_f32 v152, v152, v26, v27
    v_fma_f32 v153, v153, v26, v27
    v_fma_f32 v154, v154, v26, v27
    v_fma_f32 v155, v155, v26, v27
    s_waitcnt lgkmcnt(4)
    v_fma_f32 v148, v148, v220, v228
    v_fma_f32 v149, v149, v221, v229
    v_fma_f32 v150, v150, v222, v230
    v_fma_f32 v151, v151, v223, v231
    v_fma_f32 v152, v152, v224, v232
    v_fma_f32 v153, v153, v225, v233
    v_fma_f32 v154, v154, v226, v234
    v_fma_f32 v155, v155, v227, v235
    v_cvt_pk_bf16_f32 v112, v148, v149
    v_cvt_pk_bf16_f32 v113, v150, v151
    v_cvt_pk_bf16_f32 v114, v152, v153
    v_cvt_pk_bf16_f32 v115, v154, v155
    ds_read_b128 v[220:223], v20 offset:256
    ds_read_b128 v[224:227], v20 offset:272
    ds_read_b128 v[228:231], v20 offset:2560
    ds_read_b128 v[232:235], v20 offset:2576
    s_add_u32 m0, s41, 81920
    s_nop 0
    buffer_load_dwordx4 v22, s[16:19], s37 offen  lds
    v_lshlrev_b32 v156, 16, v116
    v_and_b32 v157, 0xffff0000, v116
    v_lshlrev_b32 v158, 16, v117
    v_and_b32 v159, 0xffff0000, v117
    v_lshlrev_b32 v160, 16, v118
    v_and_b32 v161, 0xffff0000, v118
    v_lshlrev_b32 v162, 16, v119
    v_and_b32 v163, 0xffff0000, v119
    v_mfma_f32_16x16x32_bf16 v[56:59], v[44:47], v[112:115], 0
    v_mfma_f32_16x16x32_bf16 v[60:63], v[112:115], v[112:115], 0
    v_fma_f32 v156, v156, v26, v27
    v_fma_f32 v157, v157, v26, v27
    v_fma_f32 v158, v158, v26, v27
    v_fma_f32 v159, v159, v26, v27
    v_fma_f32 v160, v160, v26, v27
    v_fma_f32 v161, v161, v26, v27
    v_fma_f32 v162, v162, v26, v27
    v_fma_f32 v163, v163, v26, v27
    s_waitcnt lgkmcnt(4)
    v_fma_f32 v156, v156, v236, v244
    v_fma_f32 v157, v157, v237, v245
    v_fma_f32 v158, v158, v238, v246
    v_fma_f32 v159, v159, v239, v247
    v_fma_f32 v160, v160, v240, v248
    v_fma_f32 v161, v161, v241, v249
    v_fma_f32 v162, v162, v242, v250
    v_fma_f32 v163, v163, v243, v251
    v_cvt_pk_bf16_f32 v116, v156, v157
    v_cvt_pk_bf16_f32 v117, v158, v159
    v_cvt_pk_bf16_f32 v118, v160, v161
    v_cvt_pk_bf16_f32 v119, v162, v163
    ds_read_b128 v[236:239], v20 offset:384
    ds_read_b128 v[240:243], v20 offset:400
    ds_read_b128 v[244:247], v20 offset:2688
    ds_read_b128 v[248:251], v20 offset:2704
    s_add_u32 m0, s41, 90112
    s_nop 0
    buffer_load_dwordx4 v23, s[16:19], s37 offen  lds
    s_add_u32 s37, s37, s38
    v_lshlrev_b32 v164, 16, v120
    v_and_b32 v165, 0xffff0000, v120
    v_lshlrev_b32 v166, 16, v121
    v_and_b32 v167, 0xffff0000, v121
    v_lshlrev_b32 v168, 16, v122
    v_and_b32 v169, 0xffff0000, v122
    v_lshlrev_b32 v170, 16, v123
    v_and_b32 v171, 0xffff0000, v123
    v_mfma_f32_16x16x32_bf16 v[56:59], v[44:47], v[116:119], v[56:59]
    v_mfma_f32_16x16x32_bf16 v[60:63], v[116:119], v[116:119], v[60:63]
    v_fma_f32 v164, v164, v26, v27
    v_fma_f32 v165, v165, v26, v27
    v_fma_f32 v166, v166, v26, v27
    v_fma_f32 v167, v167, v26, v27
    v_fma_f32 v168, v168, v26, v27
    v_fma_f32 v169, v169, v26, v27
    v_fma_f32 v170, v170, v26, v27
    v_fma_f32 v171, v171, v26, v27
    s_waitcnt lgkmcnt(4)
    v_fma_f32 v164, v164, v220, v228
    v_fma_f32 v165, v165, v221, v229
    v_fma_f32 v166, v166, v222, v230
    v_fma_f32 v167, v167, v223, v231
    v_fma_f32 v168, v168, v224, v232
    v_fma_f32 v169, v169, v225, v233
    v_fma_f32 v170, v170, v226, v234
    v_fma_f32 v171, v171, v227, v235
    v_cvt_pk_bf16_f32 v120, v164, v165
    v_cvt_pk_bf16_f32 v121, v166, v167
    v_cvt_pk_bf16_f32 v122, v168, v169
    v_cvt_pk_bf16_f32 v123, v170, v171
    ds_read_b128 v[220:223], v20 offset:512
    ds_read_b128 v[224:227], v20 offset:528
    ds_read_b128 v[228:231], v20 offset:2816
    ds_read_b128 v[232:235], v20 offset:2832
    s_add_u32 m0, s41, 98304
    s_nop 0
    buffer_load_dwordx4 v3, s[16:19], s37 offen  lds
    v_lshlrev_b32 v172, 16, v124
    v_and_b32 v173, 0xffff0000, v124
    v_lshlrev_b32 v174, 16, v125
    v_and_b32 v175, 0xffff0000, v125
    v_lshlrev_b32 v176, 16, v126
    v_and_b32 v177, 0xffff0000, v126
    v_lshlrev_b32 v178, 16, v127
    v_and_b32 v179, 0xffff0000, v127
    v_mfma_f32_16x16x32_bf16 v[56:59], v[44:47], v[120:123], v[56:59]
    v_mfma_f32_16x16x32_bf16 v[60:63], v[120:123], v[120:123], v[60:63]
    v_fma_f32 v172, v172, v26, v27
    v_fma_f32 v173, v173, v26, v27
    v_fma_f32 v174, v174, v26, v27
    v_fma_f32 v175, v175, v26, v27
    v_fma_f32 v176, v176, v26, v27
    v_fma_f32 v177, v177, v26, v27
    v_fma_f32 v178, v178, v26, v27
    v_fma_f32 v179, v179, v26, v27
    s_waitcnt lgkmcnt(4)
    v_fma_f32 v172, v172, v236, v244
    v_fma_f32 v173, v173, v237, v245
    v_fma_f32 v174, v174, v238, v246
    v_fma_f32 v175, v175, v239, v247
    v_fma_f32 v176, v176, v240, v248
    v_fma_f32 v177, v177, v241, v249
    v_fma_f32 v178, v178, v242, v250
    v_fma_f32 v179, v179, v243, v251
    v_cvt_pk_bf16_f32 v124, v172, v173
    v_cvt_pk_bf16_f32 v125, v174, v175
    v_cvt_pk_bf16_f32 v126, v176, v177
    v_cvt_pk_bf16_f32 v127, v178, v179
    ds_read_b128 v[236:239], v20 offset:640
    ds_read_b128 v[240:243], v20 offset:656
    ds_read_b128 v[244:247], v20 offset:2944
    ds_read_b128 v[248:251], v20 offset:2960
    s_add_u32 m0, s41, 106496
    s_nop 0
    buffer_load_dwordx4 v22, s[16:19], s37 offen  lds
    v_lshlrev_b32 v180, 16, v128
    v_and_b32 v181, 0xffff0000, v128
    v_lshlrev_b32 v182, 16, v129
    v_and_b32 v183, 0xffff0000, v129
    v_lshlrev_b32 v184, 16, v130
    v_and_b32 v185, 0xffff0000, v130
    v_lshlrev_b32 v186, 16, v131
    v_and_b32 v187, 0xffff0000, v131
    v_mfma_f32_16x16x32_bf16 v[56:59], v[44:47], v[124:127], v[56:59]
    v_mfma_f32_16x16x32_bf16 v[60:63], v[124:127], v[124:127], v[60:63]
    v_fma_f32 v180, v180, v26, v27
    v_fma_f32 v181, v181, v26, v27
    v_fma_f32 v182, v182, v26, v27
    v_fma_f32 v183, v183, v26, v27
    v_fma_f32 v184, v184, v26, v27
    v_fma_f32 v185, v185, v26, v27
    v_fma_f32 v186, v186, v26, v27
    v_fma_f32 v187, v187, v26, v27
    s_waitcnt lgkmcnt(4)
    v_fma_f32 v180, v180, v220, v228
    v_fma_f32 v181, v181, v221, v229
    v_fma_f32 v182, v182, v222, v230
    v_fma_f32 v183, v183, v223, v231
    v_fma_f32 v184, v184, v224, v232
    v_fma_f32 v185, v185, v225, v233
    v_fma_f32 v186, v186, v226, v234
    v_fma_f32 v187, v187, v227, v235
    v_cvt_pk_bf16_f32 v128, v180, v181
    v_cvt_pk_bf16_f32 v129, v182, v183
    v_cvt_pk_bf16_f32 v130, v184, v185
    v_cvt_pk_bf16_f32 v131, v186, v187
    ds_read_b128 v[220:223], v20 offset:768
    ds_read_b128 v[224:227], v20 offset:784
    ds_read_b128 v[228:231], v20 offset:3072
    ds_read_b128 v[232:235], v20 offset:3088
    s_add_u32 m0, s41, 114688
    s_nop 0
    buffer_load_dwordx4 v23, s[16:19], s37 offen  lds
    s_add_u32 s37, s37, s38
    v_lshlrev_b32 v188, 16, v132
    v_and_b32 v189, 0xffff0000, v132
    v_lshlrev_b32 v190, 16, v133
    v_and_b32 v191, 0xffff0000, v133
    v_lshlrev_b32 v192, 16, v134
    v_and_b32 v193, 0xffff0000, v134
    v_lshlrev_b32 v194, 16, v135
    v_and_b32 v195, 0xffff0000, v135
    v_mfma_f32_16x16x32_bf16 v[56:59], v[44:47], v[128:131], v[56:59]
    v_mfma_f32_16x16x32_bf16 v[60:63], v[128:131], v[128:131], v[60:63]
    v_fma_f32 v188, v188, v26, v27
    v_fma_f32 v189, v189, v26, v27
    v_fma_f32 v190, v190, v26, v27
    v_fma_f32 v191, v191, v26, v27
    v_fma_f32 v192, v192, v26, v27
    v_fma_f32 v193, v193, v26, v27
    v_fma_f32 v194, v194, v26, v27
    v_fma_f32 v195, v195, v26, v27
    s_waitcnt lgkmcnt(4)
    v_fma_f32 v188, v188, v236, v244
    v_fma_f32 v189, v189, v237, v245
    v_fma_f32 v190, v190, v238, v246
    v_fma_f32 v191, v191, v239, v247
    v_fma_f32 v192, v192, v240, v248
    v_fma_f32 v193, v193, v241, v249
    v_fma_f32 v194, v194, v242, v250
    v_fma_f32 v195, v195, v243, v251
    v_cvt_pk_bf16_f32 v132, v188, v189
    v_cvt_pk_bf16_f32 v133, v190, v191
    v_cvt_pk_bf16_f32 v134, v192, v193
    v_cvt_pk_bf16_f32 v135, v194, v195
    ds_read_b128 v[236:239], v20 offset:896
    ds_read_b128 v[240:243], v20 offset:912
    ds_read_b128 v[244:247], v20 offset:3200
    ds_read_b128 v[248:251], v20 offset:3216
    s_add_u32 m0, s41, 122880
    s_nop 0
    buffer_load_dwordx4 v3, s[16:19], s37 offen  lds
    v_lshlrev_b32 v196, 16, v136
    v_and_b32 v197, 0xffff0000, v136
    v_lshlrev_b32 v198, 16, v137
    v_and_b32 v199, 0xffff0000, v137
    v_lshlrev_b32 v200, 16, v138
    v_and_b32 v201, 0xffff0000, v138
    v_lshlrev_b32 v202, 16, v139
    v_and_b32 v203, 0xffff0000, v139
    v_mfma_f32_16x16x32_bf16 v[56:59], v[44:47], v[132:135], v[56:59]
    v_mfma_f32_16x16x32_bf16 v[60:63], v[132:135], v[132:135], v[60:63]
    v_fma_f32 v196, v196, v26, v27
    v_fma_f32 v197, v197, v26, v27
    v_fma_f32 v198, v198, v26, v27
    v_fma_f32 v199, v199, v26, v27
    v_fma_f32 v200, v200, v26, v27
    v_fma_f32 v201, v201, v26, v27
    v_fma_f32 v202, v202, v26, v27
    v_fma_f32 v203, v203, v26, v27
    s_waitcnt lgkmcnt(4)
    v_fma_f32 v196, v196, v220, v228
    v_fma_f32 v197, v197, v221, v229
    v_fma_f32 v198, v198, v222, v230
    v_fma_f32 v199, v199, v223, v231
    v_fma_f32 v200, v200, v224, v232
    v_fma_f32 v201, v201, v225, v233
    v_fma_f32 v202, v202, v226, v234
    v_fma_f32 v203, v203, v227, v235
    v_cvt_pk_bf16_f32 v136, v196, v197
    v_cvt_pk_bf16_f32 v137, v198, v199
    v_cvt_pk_bf16_f32 v138, v200, v201
    v_cvt_pk_bf16_f32 v139, v202, v203
    ds_read_b128 v[220:223], v20 offset:1024
    ds_read_b128 v[224:227], v20 offset:1040
    ds_read_b128 v[228:231], v20 offset:3328
    ds_read_b128 v[232:235], v20 offset:3344
    s_add_u32 m0, s41, 131072
    s_nop 0
    buffer_load_dwordx4 v22, s[16:19], s37 offen  lds
    v_lshlrev_b32 v204, 16, v140
    v_and_b32 v205, 0xffff0000, v140
    v_lshlrev_b32 v206, 16, v141
    v_and_b32 v207, 0xffff0000, v141
    v_lshlrev_b32 v208, 16, v142
    v_and_b32 v209, 0xffff0000, v142
    v_lshlrev_b32 v210, 16, v143
    v_and_b32 v211, 0xffff0000, v143
    v_mfma_f32_16x16x32_bf16 v[56:59], v[44:47], v[136:139], v[56:59]
    v_mfma_f32_16x16x32_bf16 v[60:63], v[136:139], v[136:139], v[60:63]
    v_fma_f32 v204, v204, v26, v27
    v_fma_f32 v205, v205, v26, v27
    v_fma_f32 v206, v206, v26, v27
    v_fma_f32 v207, v207, v26, v27
    v_fma_f32 v208, v208, v26, v27
    v_fma_f32 v209, v209, v26, v27
    v_fma_f32 v210, v210, v26, v27
    v_fma_f32 v211, v211, v26, v27
    s_waitcnt lgkmcnt(4)
    v_fma_f32 v204, v204, v236, v244
    v_fma_f32 v205, v205, v237, v245
    v_fma_f32 v206, v206, v238, v246
    v_fma_f32 v207, v207, v239, v247
    v_fma_f32 v208, v208, v240, v248
    v_fma_f32 v209, v209, v241, v249
    v_fma_f32 v210, v210, v242, v250
    v_fma_f32 v211, v211, v243, v251
    v_cvt_pk_bf16_f32 v140, v204, v205
    v_cvt_pk_bf16_f32 v141, v206, v207
    v_cvt_pk_bf16_f32 v142, v208, v209
    v_cvt_pk_bf16_f32 v143, v210, v211
    s_add_u32 m0, s41, 139264
    s_nop 0
    buffer_load_dwordx4 v23, s[16:19], s37 offen  lds
    s_add_u32 s63, s63, 1
    s_add_u32 s42, s63, s60
    s_and_b32 s42, s42, s61
    s_lshl_b32 s42, s42, 7
    s_add_u32 s37, s62, s42
    v_lshlrev_b32 v212, 16, v144
    v_and_b32 v213, 0xffff0000, v144
    v_lshlrev_b32 v214, 16, v145
    v_and_b32 v215, 0xffff0000, v145
    v_lshlrev_b32 v216, 16, v146
    v_and_b32 v217, 0xffff0000, v146
    v_lshlrev_b32 v218, 16, v147
    v_and_b32 v219, 0xffff0000, v147
    v_mfma_f32_16x16x32_bf16 v[56:59], v[44:47], v[140:143], v[56:59]
    v_mfma_f32_16x16x32_bf16 v[60:63], v[140:143], v[140:143], v[60:63]
    v_fma_f32 v212, v212, v26, v27
    v_fma_f32 v213, v213, v26, v27
    v_fma_f32 v214, v214, v26, v27
    v_fma_f32 v215, v215, v26, v27
    v_fma_f32 v216, v216, v26, v27
    v_fma_f32 v217, v217, v26, v27
    v_fma_f32 v218, v218, v26, v27
    v_fma_f32 v219, v219, v26, v27
    s_waitcnt lgkmcnt(0)
    v_fma_f32 v212, v212, v220, v228
    v_fma_f32 v213, v213, v221, v229
    v_fma_f32 v214, v214, v222, v230
    v_fma_f32 v215, v215, v223, v231
    v_fma_f32 v216, v216, v224, v232
    v_fma_f32 v217, v217, v225, v233
    v_fma_f32 v218, v218, v226, v234
    v_fma_f32 v219, v219, v227, v235
    v_cvt_pk_bf16_f32 v144, v212, v213
    v_cvt_pk_bf16_f32 v145, v214, v215
    v_cvt_pk_bf16_f32 v146, v216, v217
    v_cvt_pk_bf16_f32 v147, v218, v219
    s_nop 1
    v_mfma_f32_16x16x32_bf16 v[56:59], v[44:47], v[144:147], v[56:59]
    v_mfma_f32_16x16x32_bf16 v[60:63], v[144:147], v[144:147], v[60:63]
    v_mov_b32 v40, -1
    v_mov_b32 v41, -1
    v_mov_b32 v42, -1
    v_mov_b32 v43, -1
    s_lshl_b32 s48, s34, 3
    s_add_u32 s48, s48, s35
    s_mul_i32 s48, s48, 73728
    s_add_u32 s48, s48, 12582912
    v_lshlrev_b32 v34, 4, v0
    s_add_u32 s49, s35, 6
    s_and_b32 s49, s49, 7
    s_lshl_b32 s49, s49, 13
    s_add_u32 s49, s49, s48
    buffer_store_dwordx4 v[40:43], v34, s[4:7], s49 offen sc1
    s_add_u32 s49, s35, 7
    s_and_b32 s49, s49, 7
    s_lshl_b32 s49, s49, 13
    s_add_u32 s49, s49, s48
    buffer_store_dwordx4 v[40:43], v34, s[4:7], s49 offen sc1
    s_nop 7
    v_cndmask_b32 v24, v60, v61, s[52:53]
    v_cndmask_b32 v24, v24, v62, s[54:55]
    v_cndmask_b32 v25, v24, v63, s[56:57]
    v_mov_b32 v24, v56
    s_mov_b64 s[50:51], exec
    s_mov_b64 exec, s[58:59]
    ds_write_b64 v19, v[24:25] offset:1024
    s_mov_b64 exec, s[50:51]
    s_waitcnt lgkmcnt(0)
    s_barrier
    ds_read_b128 v[28:31], v18 offset:1024
    s_waitcnt lgkmcnt(0)
    v_add_f32 v24, v28, v30
    v_add_f32 v25, v29, v31
    v_mul_f32 v24, 0x3ae38e39, v24
    v_mul_f32 v25, 0x3ae38e39, v25
    v_fma_f32 v25, -v24, v24, v25
    v_max_f32 v25, 0, v25
    v_add_f32 v25, 0x3727c5ac, v25
    v_rsq_f32 v26, v25
    s_nop 0
    v_mul_f32 v27, v24, v26
    v_sub_f32 v27, 0, v27
    s_mul_i32 s48, s46, 18432
    s_mul_i32 s49, s47, 9216
    s_add_u32 s48, s48, s49
    v_lshlrev_b32 v20, 4, v1
    v_add_u32 v20, s48, v20
    v_fma_f32 v148, v148, v26, v27
    v_fma_f32 v149, v149, v26, v27
    v_fma_f32 v150, v150, v26, v27
    v_fma_f32 v151, v151, v26, v27
    v_fma_f32 v152, v152, v26, v27
    v_fma_f32 v153, v153, v26, v27
    v_fma_f32 v154, v154, v26, v27
    v_fma_f32 v155, v155, v26, v27
    v_cvt_pk_bf16_f32 v112, v148, v149
    v_cvt_pk_bf16_f32 v113, v150, v151
    v_cvt_pk_bf16_f32 v114, v152, v153
    v_cvt_pk_bf16_f32 v115, v154, v155
    ds_write_b128 v20, v[112:115] offset:0
    v_fma_f32 v156, v156, v26, v27
    v_fma_f32 v157, v157, v26, v27
    v_fma_f32 v158, v158, v26, v27
    v_fma_f32 v159, v159, v26, v27
    v_fma_f32 v160, v160, v26, v27
    v_fma_f32 v161, v161, v26, v27
    v_fma_f32 v162, v162, v26, v27
    v_fma_f32 v163, v163, v26, v27
    v_cvt_pk_bf16_f32 v116, v156, v157
    v_cvt_pk_bf16_f32 v117, v158, v159
    v_cvt_pk_bf16_f32 v118, v160, v161
    v_cvt_pk_bf16_f32 v119, v162, v163
    ds_write_b128 v20, v[116:119] offset:1024
    v_fma_f32 v164, v164, v26, v27
    v_fma_f32 v165, v165, v26, v27
    v_fma_f32 v166, v166, v26, v27
    v_fma_f32 v167, v167, v26, v27
    v_fma_f32 v168, v168, v26, v27
    v_fma_f32 v169, v169, v26, v27
    v_fma_f32 v170, v170, v26, v27
    v_fma_f32 v171, v171, v26, v27
    v_cvt_pk_bf16_f32 v120, v164, v165
    v_cvt_pk_bf16_f32 v121, v166, v167
    v_cvt_pk_bf16_f32 v122, v168, v169
    v_cvt_pk_bf16_f32 v123, v170, v171
    ds_write_b128 v20, v[120:123] offset:2048
    v_fma_f32 v172, v172, v26, v27
    v_fma_f32 v173, v173, v26, v27
    v_fma_f32 v174, v174, v26, v27
    v_fma_f32 v175, v175, v26, v27
    v_fma_f32 v176, v176, v26, v27
    v_fma_f32 v177, v177, v26, v27
    v_fma_f32 v178, v178, v26, v27
    v_fma_f32 v179, v179, v26, v27
    v_cvt_pk_bf16_f32 v124, v172, v173
    v_cvt_pk_bf16_f32 v125, v174, v175
    v_cvt_pk_bf16_f32 v126, v176, v177
    v_cvt_pk_bf16_f32 v127, v178, v179
    ds_write_b128 v20, v[124:127] offset:3072
    v_fma_f32 v180, v180, v26, v27
    v_fma_f32 v181, v181, v26, v27
    v_fma_f32 v182, v182, v26, v27
    v_fma_f32 v183, v183, v26, v27
    v_fma_f32 v184, v184, v26, v27
    v_fma_f32 v185, v185, v26, v27
    v_fma_f32 v186, v186, v26, v27
    v_fma_f32 v187, v187, v26, v27
    v_cvt_pk_bf16_f32 v128, v180, v181
    v_cvt_pk_bf16_f32 v129, v182, v183
    v_cvt_pk_bf16_f32 v130, v184, v185
    v_cvt_pk_bf16_f32 v131, v186, v187
    ds_write_b128 v20, v[128:131] offset:4096
    v_fma_f32 v188, v188, v26, v27
    v_fma_f32 v189, v189, v26, v27
    v_fma_f32 v190, v190, v26, v27
    v_fma_f32 v191, v191, v26, v27
    v_fma_f32 v192, v192, v26, v27
    v_fma_f32 v193, v193, v26, v27
    v_fma_f32 v194, v194, v26, v27
    v_fma_f32 v195, v195, v26, v27
    v_cvt_pk_bf16_f32 v132, v188, v189
    v_cvt_pk_bf16_f32 v133, v190, v191
    v_cvt_pk_bf16_f32 v134, v192, v193
    v_cvt_pk_bf16_f32 v135, v194, v195
    ds_write_b128 v20, v[132:135] offset:5120
    v_fma_f32 v196, v196, v26, v27
    v_fma_f32 v197, v197, v26, v27
    v_fma_f32 v198, v198, v26, v27
    v_fma_f32 v199, v199, v26, v27
    v_fma_f32 v200, v200, v26, v27
    v_fma_f32 v201, v201, v26, v27
    v_fma_f32 v202, v202, v26, v27
    v_fma_f32 v203, v203, v26, v27
    v_cvt_pk_bf16_f32 v136, v196, v197
    v_cvt_pk_bf16_f32 v137, v198, v199
    v_cvt_pk_bf16_f32 v138, v200, v201
    v_cvt_pk_bf16_f32 v139, v202, v203
    ds_write_b128 v20, v[136:139] offset:6144
    v_fma_f32 v204, v204, v26, v27
    v_fma_f32 v205, v205, v26, v27
    v_fma_f32 v206, v206, v26, v27
    v_fma_f32 v207, v207, v26, v27
    v_fma_f32 v208, v208, v26, v27
    v_fma_f32 v209, v209, v26, v27
    v_fma_f32 v210, v210, v26, v27
    v_fma_f32 v211, v211, v26, v27
    v_cvt_pk_bf16_f32 v140, v204, v205
    v_cvt_pk_bf16_f32 v141, v206, v207
    v_cvt_pk_bf16_f32 v142, v208, v209
    v_cvt_pk_bf16_f32 v143, v210, v211
    ds_write_b128 v20, v[140:143] offset:7168
    v_fma_f32 v212, v212, v26, v27
    v_fma_f32 v213, v213, v26, v27
    v_fma_f32 v214, v214, v26, v27
    v_fma_f32 v215, v215, v26, v27
    v_fma_f32 v216, v216, v26, v27
    v_fma_f32 v217, v217, v26, v27
    v_fma_f32 v218, v218, v26, v27
    v_fma_f32 v219, v219, v26, v27
    v_cvt_pk_bf16_f32 v144, v212, v213
    v_cvt_pk_bf16_f32 v145, v214, v215
    v_cvt_pk_bf16_f32 v146, v216, v217
    v_cvt_pk_bf16_f32 v147, v218, v219
    ds_write_b128 v20, v[144:147] offset:8192
    s_waitcnt lgkmcnt(0)
    s_barrier
    ds_read_b128 v[112:115], v12 offset:0
    ds_read_b128 v[116:119], v12 offset:1024
    ds_read_b128 v[120:123], v12 offset:2048
    ds_read_b128 v[124:127], v12 offset:3072
    ds_read_b128 v[128:131], v12 offset:4096
    ds_read_b128 v[132:135], v12 offset:5120
    ds_read_b128 v[136:139], v12 offset:6144
    ds_read_b128 v[140:143], v12 offset:7168
    ds_read_b128 v[144:147], v12 offset:8192
    ds_read_b128 v[148:151], v12 offset:9216
    ds_read_b128 v[152:155], v12 offset:10240
    ds_read_b128 v[156:159], v12 offset:11264
    ds_read_b128 v[160:163], v12 offset:12288
    ds_read_b128 v[164:167], v12 offset:13312
    ds_read_b128 v[168:171], v12 offset:14336
    ds_read_b128 v[172:175], v12 offset:15360
    ds_read_b128 v[176:179], v12 offset:16384
    ds_read_b128 v[180:183], v12 offset:17408
    ds_read_b128 v[184:187], v12 offset:18432
    ds_read_b128 v[188:191], v12 offset:19456
    ds_read_b128 v[192:195], v12 offset:20480
    ds_read_b128 v[196:199], v12 offset:21504
    ds_read_b128 v[200:203], v12 offset:22528
    ds_read_b128 v[204:207], v12 offset:23552
    ds_read_b128 v[208:211], v12 offset:24576
    ds_read_b128 v[212:215], v12 offset:25600
    ds_read_b128 v[216:219], v12 offset:26624
    ds_read_b128 v[220:223], v12 offset:27648
    ds_read_b128 v[224:227], v12 offset:28672
    ds_read_b128 v[228:231], v12 offset:29696
    ds_read_b128 v[232:235], v12 offset:30720
    ds_read_b128 v[236:239], v12 offset:31744
    ds_read_b128 v[240:243], v12 offset:32768
    ds_read_b128 v[244:247], v12 offset:33792
    ds_read_b128 v[248:251], v12 offset:34816
    ds_read_b128 v[252:255], v12 offset:35840
    ds_read_b128 v[36:39], v8
    v_add_u32 v8, 256, v8
    s_waitcnt vmcnt(8)
    s_load_dwordx2 s[8:9], s[0:1], 88
    s_load_dwordx2 s[28:29], s[0:1], 112
    s_waitcnt lgkmcnt(0)
    s_mov_b32 s10, 1152
    s_mov_b32 s11, 0x20000
    s_mov_b32 s30, 2359296
    s_mov_b32 s31, 0x20000
    s_barrier
    s_add_u32 m0, s41, 0
    s_nop 0
    buffer_load_dwordx4 v3, s[16:19], s37 offen  lds
    s_add_u32 m0, s41, 8192
    s_nop 0
    buffer_load_dwordx4 v22, s[16:19], s37 offen  lds
    s_add_u32 m0, s41, 16384
    s_nop 0
    buffer_load_dwordx4 v23, s[16:19], s37 offen  lds
    s_add_u32 s37, s37, s38
    s_add_u32 m0, s41, 24576
    s_nop 0
    buffer_load_dwordx4 v3, s[16:19], s37 offen  lds
    s_add_u32 m0, s41, 32768
    s_nop 0
    buffer_load_dwordx4 v22, s[16:19], s37 offen  lds
    s_add_u32 m0, s41, 40960
    s_nop 0
    buffer_load_dwordx4 v23, s[16:19], s37 offen  lds
    s_add_u32 s37, s37, s38
    v_mov_b32 v11, 0xbdd2d3e8
    ds_read_b64_tr_b16 v[44:45], v6 offset:24576
    ds_read_b64_tr_b16 v[46:47], v6 offset:25088
    ds_read_b64_tr_b16 v[48:49], v6 offset:28672
    ds_read_b64_tr_b16 v[50:51], v6 offset:29184
    s_mov_b32 s36, 0
    s_mov_b32 s45, 0
L_p1_0:
    s_waitcnt vmcnt(9)
    s_barrier
    s_waitcnt lgkmcnt(2)
    v_mfma_f32_16x16x32_bf16 v[56:59], v[44:47], v[112:115], v[36:39]
    ds_read_b64_tr_b16 v[52:53], v6 offset:32768
    v_mfma_f32_16x16x32_bf16 v[60:63], v[44:47], v[184:187], v[36:39]
    s_add_u32 m0, s41, 49152
    ds_read_b64_tr_b16 v[54:55], v6 offset:33280
    buffer_load_dwordx4 v3, s[16:19], s37 offen  lds
    s_waitcnt lgkmcnt(2)
    v_mfma_f32_16x16x32_bf16 v[56:59], v[48:51], v[116:119], v[56:59]
    ds_read_b64_tr_b16 v[44:45], v6 offset:36864
    v_mul_f32 v24, v64, v64
    v_mul_f32 v25, v65, v65
    v_mfma_f32_16x16x32_bf16 v[60:63], v[48:51], v[188:191], v[60:63]
    ds_read_b64_tr_b16 v[46:47], v6 offset:37376
    v_mul_f32 v26, v66, v66
    v_mul_f32 v27, v67, v67
    s_waitcnt lgkmcnt(2)
    v_mfma_f32_16x16x32_bf16 v[56:59], v[52:55], v[120:123], v[56:59]
    ds_read_b64_tr_b16 v[48:49], v6 offset:40960
    v_fma_f32 v24, v24, v11, v10
    v_mfma_f32_16x16x32_bf16 v[60:63], v[52:55], v[192:195], v[60:63]
    s_add_u32 m0, s41, 57344
    ds_read_b64_tr_b16 v[50:51], v6 offset:41472
    buffer_load_dwordx4 v22, s[16:19], s37 offen  lds
    v_fma_f32 v25, v25, v11, v10
    v_fma_f32 v26, v26, v11, v10
    s_waitcnt lgkmcnt(2)
    v_mfma_f32_16x16x32_bf16 v[56:59], v[44:47], v[124:127], v[56:59]
    ds_read_b64_tr_b16 v[52:53], v6 offset:45056
    v_fma_f32 v27, v27, v11, v10
    v_mul_f32 v24, v64, v24
    v_mfma_f32_16x16x32_bf16 v[60:63], v[44:47], v[196:199], v[60:63]
    ds_read_b64_tr_b16 v[54:55], v6 offset:45568
    v_mul_f32 v25, v65, v25
    v_mul_f32 v26, v66, v26
    s_waitcnt lgkmcnt(2)
    v_mfma_f32_16x16x32_bf16 v[56:59], v[48:51], v[128:131], v[56:59]
    ds_read_b64_tr_b16 v[44:45], v7 offset:0
    v_mul_f32 v27, v67, v27
    v_exp_f32 v24, v24
    v_mfma_f32_16x16x32_bf16 v[60:63], v[48:51], v[200:203], v[60:63]
    s_add_u32 m0, s41, 65536
    ds_read_b64_tr_b16 v[46:47], v7 offset:512
    buffer_load_dwordx4 v23, s[16:19], s37 offen  lds
    s_add_u32 s63, s63, 1
    s_add_u32 s42, s63, s60
    s_and_b32 s42, s42, s61
    s_lshl_b32 s42, s42, 7
    s_add_u32 s37, s62, s42
    v_exp_f32 v25, v25
    v_exp_f32 v26, v26
    s_waitcnt lgkmcnt(2)
    v_mfma_f32_16x16x32_bf16 v[56:59], v[52:55], v[132:135], v[56:59]
    ds_read_b64_tr_b16 v[48:49], v7 offset:4096
    v_exp_f32 v27, v27
    v_mfma_f32_16x16x32_bf16 v[60:63], v[52:55], v[204:207], v[60:63]
    ds_read_b64_tr_b16 v[50:51], v7 offset:4608
    v_add_f32 v24, 1.0, v24
    v_add_f32 v25, 1.0, v25
    s_waitcnt vmcnt(9)
    s_barrier
    s_waitcnt lgkmcnt(2)
    v_mfma_f32_16x16x32_bf16 v[56:59], v[44:47], v[136:139], v[56:59]
    ds_read_b64_tr_b16 v[52:53], v7 offset:8192
    v_add_f32 v26, 1.0, v26
    v_add_f32 v27, 1.0, v27
    v_mfma_f32_16x16x32_bf16 v[60:63], v[44:47], v[208:211], v[60:63]
    s_add_u32 m0, s41, 73728
    ds_read_b64_tr_b16 v[54:55], v7 offset:8704
    buffer_load_dwordx4 v3, s[16:19], s37 offen  lds
    v_rcp_f32 v24, v24
    v_rcp_f32 v25, v25
    s_waitcnt lgkmcnt(2)
    v_mfma_f32_16x16x32_bf16 v[56:59], v[48:51], v[140:143], v[56:59]
    ds_read_b64_tr_b16 v[44:45], v7 offset:12288
    v_rcp_f32 v26, v26
    v_rcp_f32 v27, v27
    v_mfma_f32_16x16x32_bf16 v[60:63], v[48:51], v[212:215], v[60:63]
    ds_read_b64_tr_b16 v[46:47], v7 offset:12800
    v_mul_f32 v24, v64, v24
    v_mul_f32 v25, v65, v25
    s_waitcnt lgkmcnt(2)
    v_mfma_f32_16x16x32_bf16 v[56:59], v[52:55], v[144:147], v[56:59]
    ds_read_b64_tr_b16 v[48:49], v7 offset:16384
    v_mul_f32 v26, v66, v26
    v_mfma_f32_16x16x32_bf16 v[60:63], v[52:55], v[216:219], v[60:63]
    s_add_u32 m0, s41, 81920
    ds_read_b64_tr_b16 v[50:51], v7 offset:16896
    buffer_load_dwordx4 v22, s[16:19], s37 offen  lds
    ds_read_b128 v[36:39], v8
    v_add_u32 v8, 256, v8
    v_mul_f32 v27, v67, v27
    v_cvt_pk_bf16_f32 v40, v24, v25
    s_waitcnt lgkmcnt(3)
    v_mfma_f32_16x16x32_bf16 v[56:59], v[44:47], v[148:151], v[56:59]
    ds_read_b64_tr_b16 v[52:53], v7 offset:20480
    v_cvt_pk_bf16_f32 v41, v26, v27
    s_set_gpr_idx_on s45, gpr_idx(DST)
    v_mov_b32 v72, v40
    v_mov_b32 v73, v41
    s_set_gpr_idx_off
    v_mfma_f32_16x16x32_bf16 v[60:63], v[44:47], v[220:223], v[60:63]
    ds_read_b64_tr_b16 v[54:55], v7 offset:20992
    v_mul_f32 v28, v68, v68
    v_mul_f32 v29, v69, v69
    s_waitcnt lgkmcnt(3)
    v_mfma_f32_16x16x32_bf16 v[56:59], v[48:51], v[152:155], v[56:59]
    ds_read_b64_tr_b16 v[44:45], v7 offset:24576
    v_mul_f32 v30, v70, v70
    v_mul_f32 v31, v71, v71
    v_mfma_f32_16x16x32_bf16 v[60:63], v[48:51], v[224:227], v[60:63]
    s_add_u32 m0, s41, 90112
    ds_read_b64_tr_b16 v[46:47], v7 offset:25088
    buffer_load_dwordx4 v23, s[16:19], s37 offen  lds
    s_add_u32 s37, s37, s38
    v_fma_f32 v28, v28, v11, v10
    s_waitcnt lgkmcnt(2)
    v_mfma_f32_16x16x32_bf16 v[56:59], v[52:55], v[156:159], v[56:59]
    ds_read_b64_tr_b16 v[48:49], v7 offset:28672
    v_fma_f32 v29, v29, v11, v10
    v_fma_f32 v30, v30, v11, v10
    v_mfma_f32_16x16x32_bf16 v[60:63], v[52:55], v[228:231], v[60:63]
    ds_read_b64_tr_b16 v[50:51], v7 offset:29184
    v_fma_f32 v31, v31, v11, v10
    v_mul_f32 v28, v68, v28
    s_waitcnt vmcnt(9)
    s_barrier
    s_waitcnt lgkmcnt(2)
    v_mfma_f32_16x16x32_bf16 v[56:59], v[44:47], v[160:163], v[56:59]
    ds_read_b64_tr_b16 v[52:53], v7 offset:32768
    v_mul_f32 v29, v69, v29
    v_mul_f32 v30, v70, v30
    v_mfma_f32_16x16x32_bf16 v[60:63], v[44:47], v[232:235], v[60:63]
    s_add_u32 m0, s41, 98304
    ds_read_b64_tr_b16 v[54:55], v7 offset:33280
    buffer_load_dwordx4 v3, s[16:19], s37 offen  lds
    v_mul_f32 v31, v71, v31
    v_exp_f32 v28, v28
    s_waitcnt lgkmcnt(2)
    v_mfma_f32_16x16x32_bf16 v[56:59], v[48:51], v[164:167], v[56:59]
    ds_read_b64_tr_b16 v[44:45], v7 offset:36864
    v_exp_f32 v29, v29
    v_exp_f32 v30, v30
    v_mfma_f32_16x16x32_bf16 v[60:63], v[48:51], v[236:239], v[60:63]
    ds_read_b64_tr_b16 v[46:47], v7 offset:37376
    v_exp_f32 v31, v31
    s_waitcnt lgkmcnt(2)
    v_mfma_f32_16x16x32_bf16 v[56:59], v[52:55], v[168:171], v[56:59]
    ds_read_b64_tr_b16 v[48:49], v7 offset:40960
    v_add_f32 v28, 1.0, v28
    v_add_f32 v29, 1.0, v29
    v_mfma_f32_16x16x32_bf16 v[60:63], v[52:55], v[240:243], v[60:63]
    s_add_u32 m0, s41, 106496
    ds_read_b64_tr_b16 v[50:51], v7 offset:41472
    buffer_load_dwordx4 v22, s[16:19], s37 offen  lds
    v_add_f32 v30, 1.0, v30
    v_add_f32 v31, 1.0, v31
    s_waitcnt lgkmcnt(2)
    v_mfma_f32_16x16x32_bf16 v[56:59], v[44:47], v[172:175], v[56:59]
    ds_read_b64_tr_b16 v[52:53], v7 offset:45056
    v_rcp_f32 v28, v28
    v_rcp_f32 v29, v29
    v_mfma_f32_16x16x32_bf16 v[60:63], v[44:47], v[244:247], v[60:63]
    ds_read_b64_tr_b16 v[54:55], v7 offset:45568
    v_rcp_f32 v30, v30
    v_rcp_f32 v31, v31
    s_waitcnt lgkmcnt(2)
    v_mfma_f32_16x16x32_bf16 v[56:59], v[48:51], v[176:179], v[56:59]
    ds_read_b64_tr_b16 v[44:45], v5 offset:0
    v_mul_f32 v28, v68, v28
    v_mul_f32 v29, v69, v29
    v_mfma_f32_16x16x32_bf16 v[60:63], v[48:51], v[248:251], v[60:63]
    s_add_u32 m0, s41, 114688
    ds_read_b64_tr_b16 v[46:47], v5 offset:512
    buffer_load_dwordx4 v23, s[16:19], s37 offen  lds
    s_add_u32 s37, s37, s38
    v_mul_f32 v30, v70, v30
    s_waitcnt lgkmcnt(2)
    v_mfma_f32_16x16x32_bf16 v[56:59], v[52:55], v[180:183], v[56:59]
    ds_read_b64_tr_b16 v[48:49], v5 offset:4096
    v_mul_f32 v31, v71, v31
    v_cvt_pk_bf16_f32 v40, v28, v29
    v_mfma_f32_16x16x32_bf16 v[60:63], v[52:55], v[252:255], v[60:63]
    ds_read_b64_tr_b16 v[50:51], v5 offset:4608
    v_cvt_pk_bf16_f32 v41, v30, v31
    s_set_gpr_idx_on s45, gpr_idx(DST)
    v_mov_b32 v74, v40
    v_mov_b32 v75, v41
    s_set_gpr_idx_off
    s_waitcnt vmcnt(9)
    s_barrier
    s_waitcnt lgkmcnt(2)
    v_mfma_f32_16x16x32_bf16 v[64:67], v[44:47], v[112:115], v[36:39]
    ds_read_b64_tr_b16 v[52:53], v5 offset:8192
    v_mfma_f32_16x16x32_bf16 v[68:71], v[44:47], v[184:187], v[36:39]
    s_add_u32 m0, s41, 122880
    ds_read_b64_tr_b16 v[54:55], v5 offset:8704
    buffer_load_dwordx4 v3, s[16:19], s37 offen  lds
    s_waitcnt lgkmcnt(2)
    v_mfma_f32_16x16x32_bf16 v[64:67], v[48:51], v[116:119], v[64:67]
    ds_read_b64_tr_b16 v[44:45], v5 offset:12288
    v_mul_f32 v24, v56, v56
    v_mul_f32 v25, v57, v57
    v_mfma_f32_16x16x32_bf16 v[68:71], v[48:51], v[188:191], v[68:71]
    ds_read_b64_tr_b16 v[46:47], v5 offset:12800
    v_mul_f32 v26, v58, v58
    v_mul_f32 v27, v59, v59
    s_waitcnt lgkmcnt(2)
    v_mfma_f32_16x16x32_bf16 v[64:67], v[52:55], v[120:123], v[64:67]
    ds_read_b64_tr_b16 v[48:49], v5 offset:16384
    v_fma_f32 v24, v24, v11, v10
    v_mfma_f32_16x16x32_bf16 v[68:71], v[52:55], v[192:195], v[68:71]
    s_add_u32 m0, s41, 131072
    ds_read_b64_tr_b16 v[50:51], v5 offset:16896
    buffer_load_dwordx4 v22, s[16:19], s37 offen  lds
    v_fma_f32 v25, v25, v11, v10
    v_fma_f32 v26, v26, v11, v10
    s_waitcnt lgkmcnt(2)
    v_mfma_f32_16x16x32_bf16 v[64:67], v[44:47], v[124:127], v[64:67]
    ds_read_b64_tr_b16 v[52:53], v5 offset:20480
    v_fma_f32 v27, v27, v11, v10
    v_mul_f32 v24, v56, v24
    v_mfma_f32_16x16x32_bf16 v[68:71], v[44:47], v[196:199], v[68:71]
    ds_read_b64_tr_b16 v[54:55], v5 offset:20992
    v_mul_f32 v25, v57, v25
    v_mul_f32 v26, v58, v26
    s_waitcnt lgkmcnt(2)
    v_mfma_f32_16x16x32_bf16 v[64:67], v[48:51], v[128:131], v[64:67]
    ds_read_b64_tr_b16 v[44:45], v5 offset:24576
    v_mul_f32 v27, v59, v27
    v_exp_f32 v24, v24
    v_mfma_f32_16x16x32_bf16 v[68:71], v[48:51], v[200:203], v[68:71]
    s_add_u32 m0, s41, 139264
    ds_read_b64_tr_b16 v[46:47], v5 offset:25088
    buffer_load_dwordx4 v23, s[16:19], s37 offen  lds
    s_add_u32 s63, s63, 1
    s_add_u32 s42, s63, s60
    s_and_b32 s42, s42, s61
    s_lshl_b32 s42, s42, 7
    s_add_u32 s37, s62, s42
    v_exp_f32 v25, v25
    v_exp_f32 v26, v26
    s_waitcnt lgkmcnt(2)
    v_mfma_f32_16x16x32_bf16 v[64:67], v[52:55], v[132:135], v[64:67]
    ds_read_b64_tr_b16 v[48:49], v5 offset:28672
    v_exp_f32 v27, v27
    v_mfma_f32_16x16x32_bf16 v[68:71], v[52:55], v[204:207], v[68:71]
    ds_read_b64_tr_b16 v[50:51], v5 offset:29184
    v_add_f32 v24, 1.0, v24
    v_add_f32 v25, 1.0, v25
    s_waitcnt vmcnt(9)
    s_barrier
    s_cmp_eq_u32 s36, 3
    s_cbranch_scc0 L_sw_w2_0
    s_mov_b32 s16, s12
    s_mov_b32 s17, s13
    v_mov_b32 v3, v4
    v_add_u32 v22, 73728, v4
    v_add_u32 v23, 147456, v4
    s_mul_i32 s62, s35, 663552
    s_mov_b32 s38, 221184
    s_mov_b32 s63, 0
    s_add_u32 s37, s62, 1024
    s_mov_b32 s60, s35
    s_mov_b32 s61, 7
L_sw_w2_0:
    s_waitcnt lgkmcnt(2)
    v_mfma_f32_16x16x32_bf16 v[64:67], v[44:47], v[136:139], v[64:67]
    ds_read_b64_tr_b16 v[52:53], v5 offset:32768
    v_add_f32 v26, 1.0, v26
    v_add_f32 v27, 1.0, v27
    v_mfma_f32_16x16x32_bf16 v[68:71], v[44:47], v[208:211], v[68:71]
    s_add_u32 m0, s41, 0
    ds_read_b64_tr_b16 v[54:55], v5 offset:33280
    buffer_load_dwordx4 v3, s[16:19], s37 offen  lds
    v_rcp_f32 v24, v24
    v_rcp_f32 v25, v25
    s_waitcnt lgkmcnt(2)
    v_mfma_f32_16x16x32_bf16 v[64:67], v[48:51], v[140:143], v[64:67]
    ds_read_b64_tr_b16 v[44:45], v5 offset:36864
    v_rcp_f32 v26, v26
    v_rcp_f32 v27, v27
    v_mfma_f32_16x16x32_bf16 v[68:71], v[48:51], v[212:215], v[68:71]
    ds_read_b64_tr_b16 v[46:47], v5 offset:37376
    v_mul_f32 v24, v56, v24
    v_mul_f32 v25, v57, v25
    s_waitcnt lgkmcnt(2)
    v_mfma_f32_16x16x32_bf16 v[64:67], v[52:55], v[144:147], v[64:67]
    ds_read_b64_tr_b16 v[48:49], v5 offset:40960
    v_mul_f32 v26, v58, v26
    v_mfma_f32_16x16x32_bf16 v[68:71], v[52:55], v[216:219], v[68:71]
    s_add_u32 m0, s41, 8192
    ds_read_b64_tr_b16 v[50:51], v5 offset:41472
    buffer_load_dwordx4 v22, s[16:19], s37 offen  lds
    ds_read_b128 v[36:39], v8
    v_add_u32 v8, 256, v8
    v_mul_f32 v27, v59, v27
    v_cvt_pk_bf16_f32 v40, v24, v25
    s_waitcnt lgkmcnt(3)
    v_mfma_f32_16x16x32_bf16 v[64:67], v[44:47], v[148:151], v[64:67]
    ds_read_b64_tr_b16 v[52:53], v5 offset:45056
    v_cvt_pk_bf16_f32 v41, v26, v27
    s_set_gpr_idx_on s45, gpr_idx(DST)
    v_mov_b32 v76, v40
    v_mov_b32 v77, v41
    s_set_gpr_idx_off
    v_mfma_f32_16x16x32_bf16 v[68:71], v[44:47], v[220:223], v[68:71]
    ds_read_b64_tr_b16 v[54:55], v5 offset:45568
    v_mul_f32 v28, v60, v60
    v_mul_f32 v29, v61, v61
    s_waitcnt lgkmcnt(3)
    v_mfma_f32_16x16x32_bf16 v[64:67], v[48:51], v[152:155], v[64:67]
    ds_read_b64_tr_b16 v[44:45], v6 offset:0
    v_mul_f32 v30, v62, v62
    v_mul_f32 v31, v63, v63
    v_mfma_f32_16x16x32_bf16 v[68:71], v[48:51], v[224:227], v[68:71]
    s_add_u32 m0, s41, 16384
    ds_read_b64_tr_b16 v[46:47], v6 offset:512
    buffer_load_dwordx4 v23, s[16:19], s37 offen  lds
    s_add_u32 s37, s37, s38
    v_fma_f32 v28, v28, v11, v10
    s_waitcnt lgkmcnt(2)
    v_mfma_f32_16x16x32_bf16 v[64:67], v[52:55], v[156:159], v[64:67]
    ds_read_b64_tr_b16 v[48:49], v6 offset:4096
    v_fma_f32 v29, v29, v11, v10
    v_fma_f32 v30, v30, v11, v10
    v_mfma_f32_16x16x32_bf16 v[68:71], v[52:55], v[228:231], v[68:71]
    ds_read_b64_tr_b16 v[50:51], v6 offset:4608
    v_fma_f32 v31, v31, v11, v10
    v_mul_f32 v28, v60, v28
    s_waitcnt vmcnt(9)
    s_barrier
    s_waitcnt lgkmcnt(2)
    v_mfma_f32_16x16x32_bf16 v[64:67], v[44:47], v[160:163], v[64:67]
    ds_read_b64_tr_b16 v[52:53], v6 offset:8192
    v_mul_f32 v29, v61, v29
    v_mul_f32 v30, v62, v30
    v_mfma_f32_16x16x32_bf16 v[68:71], v[44:47], v[232:235], v[68:71]
    s_add_u32 m0, s41, 24576
    ds_read_b64_tr_b16 v[54:55], v6 offset:8704
    buffer_load_dwordx4 v3, s[16:19], s37 offen  lds
    v_mul_f32 v31, v63, v31
    v_exp_f32 v28, v28
    s_waitcnt lgkmcnt(2)
    v_mfma_f32_16x16x32_bf16 v[64:67], v[48:51], v[164:167], v[64:67]
    ds_read_b64_tr_b16 v[44:45], v6 offset:12288
    v_exp_f32 v29, v29
    v_exp_f32 v30, v30
    v_mfma_f32_16x16x32_bf16 v[68:71], v[48:51], v[236:239], v[68:71]
    ds_read_b64_tr_b16 v[46:47], v6 offset:12800
    v_exp_f32 v31, v31
    s_waitcnt lgkmcnt(2)
    v_mfma_f32_16x16x32_bf16 v[64:67], v[52:55], v[168:171], v[64:67]
    ds_read_b64_tr_b16 v[48:49], v6 offset:16384
    v_add_f32 v28, 1.0, v28
    v_add_f32 v29, 1.0, v29
    v_mfma_f32_16x16x32_bf16 v[68:71], v[52:55], v[240:243], v[68:71]
    s_add_u32 m0, s41, 32768
    ds_read_b64_tr_b16 v[50:51], v6 offset:16896
    buffer_load_dwordx4 v22, s[16:19], s37 offen  lds
    v_add_f32 v30, 1.0, v30
    v_add_f32 v31, 1.0, v31
    s_waitcnt lgkmcnt(2)
    v_mfma_f32_16x16x32_bf16 v[64:67], v[44:47], v[172:175], v[64:67]
    ds_read_b64_tr_b16 v[52:53], v6 offset:20480
    v_rcp_f32 v28, v28
    v_rcp_f32 v29, v29
    v_mfma_f32_16x16x32_bf16 v[68:71], v[44:47], v[244:247], v[68:71]
    ds_read_b64_tr_b16 v[54:55], v6 offset:20992
    v_rcp_f32 v30, v30
    v_rcp_f32 v31, v31
    s_waitcnt lgkmcnt(2)
    v_mfma_f32_16x16x32_bf16 v[64:67], v[48:51], v[176:179], v[64:67]
    ds_read_b64_tr_b16 v[44:45], v6 offset:24576
    v_mul_f32 v28, v60, v28
    v_mul_f32 v29, v61, v29
    v_mfma_f32_16x16x32_bf16 v[68:71], v[48:51], v[248:251], v[68:71]
    s_add_u32 m0, s41, 40960
    ds_read_b64_tr_b16 v[46:47], v6 offset:25088
    buffer_load_dwordx4 v23, s[16:19], s37 offen  lds
    s_add_u32 s37, s37, s38
    v_mul_f32 v30, v62, v30
    s_waitcnt lgkmcnt(2)
    v_mfma_f32_16x16x32_bf16 v[64:67], v[52:55], v[180:183], v[64:67]
    ds_read_b64_tr_b16 v[48:49], v6 offset:28672
    v_mul_f32 v31, v63, v31
    v_cvt_pk_bf16_f32 v40, v28, v29
    v_mfma_f32_16x16x32_bf16 v[68:71], v[52:55], v[252:255], v[68:71]
    ds_read_b64_tr_b16 v[50:51], v6 offset:29184
    v_cvt_pk_bf16_f32 v41, v30, v31
    s_set_gpr_idx_on s45, gpr_idx(DST)
    v_mov_b32 v78, v40
    v_mov_b32 v79, v41
    s_set_gpr_idx_off
    s_add_u32 s45, s45, 8
    s_add_u32 s36, s36, 1
    s_cmp_lt_u32 s36, 4
    s_cbranch_scc1 L_p1_0
    s_waitcnt vmcnt(9)
    s_barrier
    s_waitcnt lgkmcnt(2)
    v_mfma_f32_16x16x32_bf16 v[56:59], v[44:47], v[112:115], v[36:39]
    ds_read_b64_tr_b16 v[52:53], v6 offset:32768
    v_mfma_f32_16x16x32_bf16 v[60:63], v[44:47], v[184:187], v[36:39]
    s_add_u32 m0, s41, 49152
    ds_read_b64_tr_b16 v[54:55], v6 offset:33280
    buffer_load_dwordx4 v3, s[16:19], s37 offen  lds
    s_waitcnt lgkmcnt(2)
    v_mfma_f32_16x16x32_bf16 v[56:59], v[48:51], v[116:119], v[56:59]
    ds_read_b64_tr_b16 v[44:45], v6 offset:36864
    v_mul_f32 v24, v64, v64
    v_mul_f32 v25, v65, v65
    v_mfma_f32_16x16x32_bf16 v[60:63], v[48:51], v[188:191], v[60:63]
    ds_read_b64_tr_b16 v[46:47], v6 offset:37376
    v_mul_f32 v26, v66, v66
    v_mul_f32 v27, v67, v67
    s_waitcnt lgkmcnt(2)
    v_mfma_f32_16x16x32_bf16 v[56:59], v[52:55], v[120:123], v[56:59]
    ds_read_b64_tr_b16 v[48:49], v6 offset:40960
    v_fma_f32 v24, v24, v11, v10
    v_mfma_f32_16x16x32_bf16 v[60:63], v[52:55], v[192:195], v[60:63]
    s_add_u32 m0, s41, 57344
    ds_read_b64_tr_b16 v[50:51], v6 offset:41472
    buffer_load_dwordx4 v22, s[16:19], s37 offen  lds
    v_fma_f32 v25, v25, v11, v10
    v_fma_f32 v26, v26, v11, v10
    s_waitcnt lgkmcnt(2)
    v_mfma_f32_16x16x32_bf16 v[56:59], v[44:47], v[124:127], v[56:59]
    ds_read_b64_tr_b16 v[52:53], v6 offset:45056
    v_fma_f32 v27, v27, v11, v10
    v_mul_f32 v24, v64, v24
    v_mfma_f32_16x16x32_bf16 v[60:63], v[44:47], v[196:199], v[60:63]
    ds_read_b64_tr_b16 v[54:55], v6 offset:45568
    v_mul_f32 v25, v65, v25
    v_mul_f32 v26, v66, v26
    s_waitcnt lgkmcnt(2)
    v_mfma_f32_16x16x32_bf16 v[56:59], v[48:51], v[128:131], v[56:59]
    ds_read_b64_tr_b16 v[44:45], v7 offset:0
    v_mul_f32 v27, v67, v27
    v_mfma_f32_16x16x32_bf16 v[60:63], v[48:51], v[200:203], v[60:63]
    s_add_u32 m0, s41, 65536
    ds_read_b64_tr_b16 v[46:47], v7 offset:512
    buffer_load_dwordx4 v23, s[16:19], s37 offen  lds
    s_add_u32 s63, s63, 1
    s_add_u32 s42, s63, s60
    s_and_b32 s42, s42, s61
    s_lshl_b32 s42, s42, 7
    s_add_u32 s37, s62, s42
    v_exp_f32 v24, v24
    v_exp_f32 v25, v25
    s_waitcnt lgkmcnt(2)
    v_mfma_f32_16x16x32_bf16 v[56:59], v[52:55], v[132:135], v[56:59]
    ds_read_b64_tr_b16 v[48:49], v7 offset:4096
    v_exp_f32 v26, v26
    v_exp_f32 v27, v27
    v_mfma_f32_16x16x32_bf16 v[60:63], v[52:55], v[204:207], v[60:63]
    ds_read_b64_tr_b16 v[50:51], v7 offset:4608
    v_add_f32 v24, 1.0, v24
    v_add_f32 v25, 1.0, v25
    s_waitcnt vmcnt(9)
    s_barrier
    s_waitcnt lgkmcnt(2)
    v_mfma_f32_16x16x32_bf16 v[56:59], v[44:47], v[136:139], v[56:59]
    ds_read_b64_tr_b16 v[52:53], v7 offset:8192
    v_add_f32 v26, 1.0, v26
    v_mfma_f32_16x16x32_bf16 v[60:63], v[44:47], v[208:211], v[60:63]
    ds_read_b64_tr_b16 v[54:55], v7 offset:8704
    v_add_f32 v27, 1.0, v27
    v_rcp_f32 v24, v24
    s_waitcnt lgkmcnt(2)
    v_mfma_f32_16x16x32_bf16 v[56:59], v[48:51], v[140:143], v[56:59]
    ds_read_b64_tr_b16 v[44:45], v7 offset:12288
    v_rcp_f32 v25, v25
    v_rcp_f32 v26, v26
    v_mfma_f32_16x16x32_bf16 v[60:63], v[48:51], v[212:215], v[60:63]
    ds_read_b64_tr_b16 v[46:47], v7 offset:12800
    v_rcp_f32 v27, v27
    v_mul_f32 v24, v64, v24
    s_waitcnt lgkmcnt(2)
    v_mfma_f32_16x16x32_bf16 v[56:59], v[52:55], v[144:147], v[56:59]
    ds_read_b64_tr_b16 v[48:49], v7 offset:16384
    v_mul_f32 v25, v65, v25
    v_mfma_f32_16x16x32_bf16 v[60:63], v[52:55], v[216:219], v[60:63]
    ds_read_b64_tr_b16 v[50:51], v7 offset:16896
    ds_read_b128 v[36:39], v8
    v_add_u32 v8, 256, v8
    v_mul_f32 v26, v66, v26
    v_mul_f32 v27, v67, v27
    s_waitcnt lgkmcnt(3)
    v_mfma_f32_16x16x32_bf16 v[56:59], v[44:47], v[148:151], v[56:59]
    ds_read_b64_tr_b16 v[52:53], v7 offset:20480
    v_cvt_pk_bf16_f32 v104, v24, v25
    v_cvt_pk_bf16_f32 v105, v26, v27
    v_mfma_f32_16x16x32_bf16 v[60:63], v[44:47], v[220:223], v[60:63]
    ds_read_b64_tr_b16 v[54:55], v7 offset:20992
    v_mul_f32 v28, v68, v68
    v_mul_f32 v29, v69, v69
    s_waitcnt lgkmcnt(3)
    v_mfma_f32_16x16x32_bf16 v[56:59], v[48:51], v[152:155], v[56:59]
    ds_read_b64_tr_b16 v[44:45], v7 offset:24576
    v_mul_f32 v30, v70, v70
    v_mul_f32 v31, v71, v71
    v_mfma_f32_16x16x32_bf16 v[60:63], v[48:51], v[224:227], v[60:63]
    ds_read_b64_tr_b16 v[46:47], v7 offset:25088
    v_fma_f32 v28, v28, v11, v10
    s_waitcnt lgkmcnt(2)
    v_mfma_f32_16x16x32_bf16 v[56:59], v[52:55], v[156:159], v[56:59]
    ds_read_b64_tr_b16 v[48:49], v7 offset:28672
    v_fma_f32 v29, v29, v11, v10
    v_fma_f32 v30, v30, v11, v10
    v_mfma_f32_16x16x32_bf16 v[60:63], v[52:55], v[228:231], v[60:63]
    ds_read_b64_tr_b16 v[50:51], v7 offset:29184
    v_fma_f32 v31, v31, v11, v10
    v_mul_f32 v28, v68, v28
    s_waitcnt vmcnt(6)
    s_barrier
    s_waitcnt lgkmcnt(2)
    v_mfma_f32_16x16x32_bf16 v[56:59], v[44:47], v[160:163], v[56:59]
    ds_read_b64_tr_b16 v[52:53], v7 offset:32768
    v_mul_f32 v29, v69, v29
    v_mul_f32 v30, v70, v30
    v_mfma_f32_16x16x32_bf16 v[60:63], v[44:47], v[232:235], v[60:63]
    ds_read_b64_tr_b16 v[54:55], v7 offset:33280
    v_mul_f32 v31, v71, v31
    s_waitcnt lgkmcnt(2)
    v_mfma_f32_16x16x32_bf16 v[56:59], v[48:51], v[164:167], v[56:59]
    ds_read_b64_tr_b16 v[44:45], v7 offset:36864
    v_exp_f32 v28, v28
    v_exp_f32 v29, v29
    v_mfma_f32_16x16x32_bf16 v[60:63], v[48:51], v[236:239], v[60:63]
    ds_read_b64_tr_b16 v[46:47], v7 offset:37376
    v_exp_f32 v30, v30
    v_exp_f32 v31, v31
    s_waitcnt lgkmcnt(2)
    v_mfma_f32_16x16x32_bf16 v[56:59], v[52:55], v[168:171], v[56:59]
    ds_read_b64_tr_b16 v[48:49], v7 offset:40960
    v_add_f32 v28, 1.0, v28
    v_add_f32 v29, 1.0, v29
    v_mfma_f32_16x16x32_bf16 v[60:63], v[52:55], v[240:243], v[60:63]
    ds_read_b64_tr_b16 v[50:51], v7 offset:41472
    v_add_f32 v30, 1.0, v30
    s_waitcnt lgkmcnt(2)
    v_mfma_f32_16x16x32_bf16 v[56:59], v[44:47], v[172:175], v[56:59]
    ds_read_b64_tr_b16 v[52:53], v7 offset:45056
    v_add_f32 v31, 1.0, v31
    v_rcp_f32 v28, v28
    v_mfma_f32_16x16x32_bf16 v[60:63], v[44:47], v[244:247], v[60:63]
    ds_read_b64_tr_b16 v[54:55], v7 offset:45568
    v_rcp_f32 v29, v29
    v_rcp_f32 v30, v30
    s_waitcnt lgkmcnt(2)
    v_mfma_f32_16x16x32_bf16 v[56:59], v[48:51], v[176:179], v[56:59]
    ds_read_b64_tr_b16 v[44:45], v5 offset:0
    v_rcp_f32 v31, v31
    v_mul_f32 v28, v68, v28
    v_mfma_f32_16x16x32_bf16 v[60:63], v[48:51], v[248:251], v[60:63]
    ds_read_b64_tr_b16 v[46:47], v5 offset:512
    v_mul_f32 v29, v69, v29
    s_waitcnt lgkmcnt(2)
    v_mfma_f32_16x16x32_bf16 v[56:59], v[52:55], v[180:183], v[56:59]
    ds_read_b64_tr_b16 v[48:49], v5 offset:4096
    v_mul_f32 v30, v70, v30
    v_mul_f32 v31, v71, v31
    v_mfma_f32_16x16x32_bf16 v[60:63], v[52:55], v[252:255], v[60:63]
    ds_read_b64_tr_b16 v[50:51], v5 offset:4608
    v_cvt_pk_bf16_f32 v106, v28, v29
    v_cvt_pk_bf16_f32 v107, v30, v31
    s_waitcnt vmcnt(3)
    s_barrier
    s_nop 3
    ds_write_b64 v13, v[76:77] offset:0
    v_mul_f32 v24, v56, v56
    v_mul_f32 v25, v57, v57
    v_mul_f32 v26, v58, v58
    ds_write_b64 v13, v[78:79] offset:18432
    v_mul_f32 v27, v59, v59
    v_fma_f32 v24, v24, v11, v10
    v_fma_f32 v25, v25, v11, v10
    v_fma_f32 v26, v26, v11, v10
    ds_write_b64 v13, v[80:81] offset:2048
    v_fma_f32 v27, v27, v11, v10
    v_mul_f32 v24, v56, v24
    v_mul_f32 v25, v57, v25
    v_mul_f32 v26, v58, v26
    ds_write_b64 v13, v[82:83] offset:20480
    v_mul_f32 v27, v59, v27
    v_exp_f32 v24, v24
    v_exp_f32 v25, v25
    v_exp_f32 v26, v26
    ds_write_b64 v13, v[84:85] offset:4096
    v_exp_f32 v27, v27
    v_add_f32 v24, 1.0, v24
    v_add_f32 v25, 1.0, v25
    ds_write_b64 v13, v[86:87] offset:22528
    v_add_f32 v26, 1.0, v26
    v_add_f32 v27, 1.0, v27
    v_rcp_f32 v24, v24
    v_rcp_f32 v25, v25
    ds_write_b64 v13, v[88:89] offset:6144
    v_rcp_f32 v26, v26
    v_rcp_f32 v27, v27
    v_mul_f32 v24, v56, v24
    v_mul_f32 v25, v57, v25
    ds_write_b64 v13, v[90:91] offset:24576
    v_mul_f32 v26, v58, v26
    v_mul_f32 v27, v59, v27
    v_cvt_pk_bf16_f32 v108, v24, v25
    v_cvt_pk_bf16_f32 v109, v26, v27
    ds_write_b64 v13, v[92:93] offset:8192
    v_mul_f32 v28, v60, v60
    v_mul_f32 v29, v61, v61
    v_mul_f32 v30, v62, v62
    ds_write_b64 v13, v[94:95] offset:26624
    v_mul_f32 v31, v63, v63
    v_fma_f32 v28, v28, v11, v10
    v_fma_f32 v29, v29, v11, v10
    v_fma_f32 v30, v30, v11, v10
    ds_write_b64 v13, v[96:97] offset:10240
    v_fma_f32 v31, v31, v11, v10
    v_mul_f32 v28, v60, v28
    v_mul_f32 v29, v61, v29
    v_mul_f32 v30, v62, v30
    ds_write_b64 v13, v[98:99] offset:28672
    v_mul_f32 v31, v63, v31
    v_exp_f32 v28, v28
    v_exp_f32 v29, v29
    v_exp_f32 v30, v30
    ds_write_b64 v13, v[100:101] offset:12288
    v_exp_f32 v31, v31
    v_add_f32 v28, 1.0, v28
    v_add_f32 v29, 1.0, v29
    ds_write_b64 v13, v[102:103] offset:30720
    v_add_f32 v30, 1.0, v30
    v_add_f32 v31, 1.0, v31
    v_rcp_f32 v28, v28
    v_rcp_f32 v29, v29
    ds_write_b64 v13, v[104:105] offset:14336
    v_rcp_f32 v30, v30
    v_rcp_f32 v31, v31
    v_mul_f32 v28, v60, v28
    v_mul_f32 v29, v61, v29
    ds_write_b64 v13, v[106:107] offset:32768
    v_mul_f32 v30, v62, v30
    v_mul_f32 v31, v63, v31
    v_cvt_pk_bf16_f32 v110, v28, v29
    v_cvt_pk_bf16_f32 v111, v30, v31
    ds_write_b64 v13, v[108:109] offset:16384
    ds_write_b64 v13, v[110:111] offset:34816
    s_waitcnt lgkmcnt(0)
    s_barrier
    v_add_u32 v12, 73728, v12
    ds_read_b128 v[112:115], v12 offset:0
    ds_read_b128 v[116:119], v12 offset:1024
    ds_read_b128 v[120:123], v12 offset:2048
    ds_read_b128 v[124:127], v12 offset:3072
    ds_read_b128 v[128:131], v12 offset:4096
    ds_read_b128 v[132:135], v12 offset:5120
    ds_read_b128 v[136:139], v12 offset:6144
    ds_read_b128 v[140:143], v12 offset:7168
    ds_read_b128 v[144:147], v12 offset:8192
    ds_read_b128 v[148:151], v12 offset:9216
    ds_read_b128 v[152:155], v12 offset:10240
    ds_read_b128 v[156:159], v12 offset:11264
    ds_read_b128 v[160:163], v12 offset:12288
    ds_read_b128 v[164:167], v12 offset:13312
    ds_read_b128 v[168:171], v12 offset:14336
    ds_read_b128 v[172:175], v12 offset:15360
    ds_read_b128 v[176:179], v12 offset:16384
    ds_read_b128 v[180:183], v12 offset:17408
    ds_read_b128 v[184:187], v12 offset:18432
    ds_read_b128 v[188:191], v12 offset:19456
    ds_read_b128 v[192:195], v12 offset:20480
    ds_read_b128 v[196:199], v12 offset:21504
    ds_read_b128 v[200:203], v12 offset:22528
    ds_read_b128 v[204:207], v12 offset:23552
    ds_read_b128 v[208:211], v12 offset:24576
    ds_read_b128 v[212:215], v12 offset:25600
    ds_read_b128 v[216:219], v12 offset:26624
    ds_read_b128 v[220:223], v12 offset:27648
    ds_read_b128 v[224:227], v12 offset:28672
    ds_read_b128 v[228:231], v12 offset:29696
    ds_read_b128 v[232:235], v12 offset:30720
    ds_read_b128 v[236:239], v12 offset:31744
    ds_read_b128 v[240:243], v12 offset:32768
    ds_read_b128 v[244:247], v12 offset:33792
    ds_read_b128 v[248:251], v12 offset:34816
    ds_read_b128 v[252:255], v12 offset:35840
    s_waitcnt lgkmcnt(0)
    s_barrier
    s_add_u32 m0, s41, 73728
    s_nop 0
    buffer_load_dwordx4 v3, s[16:19], s37 offen  lds
    s_add_u32 m0, s41, 81920
    s_nop 0
    buffer_load_dwordx4 v22, s[16:19], s37 offen  lds
    s_add_u32 m0, s41, 90112
    s_nop 0
    buffer_load_dwordx4 v23, s[16:19], s37 offen  lds
    s_add_u32 s37, s37, s38
    s_add_u32 m0, s41, 98304
    s_nop 0
    buffer_load_dwordx4 v3, s[16:19], s37 offen  lds
    s_add_u32 m0, s41, 106496
    s_nop 0
    buffer_load_dwordx4 v22, s[16:19], s37 offen  lds
    s_add_u32 m0, s41, 114688
    s_nop 0
    buffer_load_dwordx4 v23, s[16:19], s37 offen  lds
    s_add_u32 s37, s37, s38
    s_mov_b32 s36, 0
    s_mov_b32 s32, s44
    s_add_u32 s44, s44, 65536
    s_mov_b32 s59, 0
    s_lshl_b32 s46, s34, 7
    s_add_u32 s46, s46, 12320768
    v_and_b32 v12, 7, v1
    v_lshlrev_b32 v12, 2, v12
    v_lshlrev_b32 v13, 4, v1
    s_lshr_b32 s52, s35, 2
    s_and_b32 s53, s35, 3
    s_lshl_b32 s54, s34, 6
    s_lshl_b32 s55, s52, 5
    s_add_u32 s54, s54, s55
    v_add_u32 v8, s54, v14
    v_mul_u32_u24 v8, 1152, v8
    s_lshl_b32 s55, s53, 4
    v_lshlrev_b32 v21, 2, v15
    v_add_u32 v21, s55, v21
    v_lshlrev_b32 v16, 1, v21
    v_add_u32 v8, v8, v16
    v_lshrrev_b32 v20, 2, v14
    v_lshlrev_b32 v16, 2, v15
    v_add_u32 v20, v20, v16
    v_lshlrev_b32 v20, 6, v20
    v_and_b32 v16, 3, v1
    v_lshlrev_b32 v16, 3, v16
    v_add_u32 v20, v20, v16
    v_add_u32 v20, 147456, v20
    v_lshrrev_b32 v19, 2, v1
    v_lshlrev_b32 v19, 7, v19
    v_and_b32 v16, 3, v1
    v_lshlrev_b32 v16, 4, v16
    v_add_u32 v19, v19, v16
    s_lshl_b32 s55, s52, 6
    v_add_u32 v19, s55, v19
L_p2_0:
    s_waitcnt vmcnt(9)
    s_barrier
    s_waitcnt lgkmcnt(2)
    v_mfma_f32_16x16x32_bf16 v[56:59], v[44:47], v[112:115], 0
    ds_read_b64_tr_b16 v[52:53], v5 offset:8192
    v_mfma_f32_16x16x32_bf16 v[60:63], v[44:47], v[184:187], 0
    s_add_u32 m0, s41, 122880
    ds_read_b64_tr_b16 v[54:55], v5 offset:8704
    buffer_load_dwordx4 v3, s[16:19], s37 offen  lds
    s_waitcnt lgkmcnt(2)
    v_mfma_f32_16x16x32_bf16 v[56:59], v[48:51], v[116:119], v[56:59]
    ds_read_b64_tr_b16 v[44:45], v5 offset:12288
    v_cvt_pk_bf16_f32 v40, v64, v65
    v_mfma_f32_16x16x32_bf16 v[60:63], v[48:51], v[188:191], v[60:63]
    ds_read_b64_tr_b16 v[46:47], v5 offset:12800
    v_cvt_pk_bf16_f32 v41, v66, v67
    s_waitcnt lgkmcnt(2)
    v_mfma_f32_16x16x32_bf16 v[56:59], v[52:55], v[120:123], v[56:59]
    ds_read_b64_tr_b16 v[48:49], v5 offset:16384
    v_mfma_f32_16x16x32_bf16 v[60:63], v[52:55], v[192:195], v[60:63]
    s_add_u32 m0, s41, 131072
    ds_read_b64_tr_b16 v[50:51], v5 offset:16896
    buffer_load_dwordx4 v22, s[16:19], s37 offen  lds
    v_cvt_pk_bf16_f32 v42, v68, v69
    s_waitcnt lgkmcnt(2)
    v_mfma_f32_16x16x32_bf16 v[56:59], v[44:47], v[124:127], v[56:59]
    ds_read_b64_tr_b16 v[52:53], v5 offset:20480
    v_cvt_pk_bf16_f32 v43, v70, v71
    v_mfma_f32_16x16x32_bf16 v[60:63], v[44:47], v[196:199], v[60:63]
    ds_read_b64_tr_b16 v[54:55], v5 offset:20992
    buffer_store_dwordx4 v[40:43], v9, s[4:7], s43 offen sc1
    s_mov_b32 s43, s44
    s_add_u32 s59, s59, 1
    s_add_u32 s44, s59, s35
    s_and_b32 s44, s44, 7
    s_lshl_b32 s44, s44, 13
    s_add_u32 s44, s44, s32
    s_waitcnt lgkmcnt(2)
    v_mfma_f32_16x16x32_bf16 v[56:59], v[48:51], v[128:131], v[56:59]
    ds_read_b64_tr_b16 v[44:45], v5 offset:24576
    v_mfma_f32_16x16x32_bf16 v[60:63], v[48:51], v[200:203], v[60:63]
    s_add_u32 m0, s41, 139264
    ds_read_b64_tr_b16 v[46:47], v5 offset:25088
    buffer_load_dwordx4 v23, s[16:19], s37 offen  lds
    s_add_u32 s63, s63, 1
    s_add_u32 s42, s63, s60
    s_and_b32 s42, s42, s61
    s_lshl_b32 s42, s42, 7
    s_add_u32 s37, s62, s42
    s_waitcnt lgkmcnt(2)
    v_mfma_f32_16x16x32_bf16 v[56:59], v[52:55], v[132:135], v[56:59]
    ds_read_b64_tr_b16 v[48:49], v5 offset:28672
    v_mfma_f32_16x16x32_bf16 v[60:63], v[52:55], v[204:207], v[60:63]
    ds_read_b64_tr_b16 v[50:51], v5 offset:29184
    s_waitcnt vmcnt(9)
    s_barrier
    s_cmp_eq_u32 s36, 2
    s_cbranch_scc0 L_siga
    s_cmp_eq_u32 s33, 0
    s_cbranch_scc0 L_siga
    s_lshl_b32 s52, s35, 2
    s_add_u32 s52, s52, s46
    v_mov_b32 v16, 1
    v_mov_b32 v17, 0
    s_mov_b64 exec, 1
    buffer_store_dword v16, v17, s[4:7], s52 offen sc1
    s_mov_b64 exec, -1
L_siga:
    s_waitcnt lgkmcnt(2)
    v_mfma_f32_16x16x32_bf16 v[56:59], v[44:47], v[136:139], v[56:59]
    ds_read_b64_tr_b16 v[52:53], v5 offset:32768
    v_mfma_f32_16x16x32_bf16 v[60:63], v[44:47], v[208:211], v[60:63]
    s_add_u32 m0, s41, 0
    ds_read_b64_tr_b16 v[54:55], v5 offset:33280
    buffer_load_dwordx4 v3, s[16:19], s37 offen  lds
    s_waitcnt lgkmcnt(2)
    v_mfma_f32_16x16x32_bf16 v[56:59], v[48:51], v[140:143], v[56:59]
    ds_read_b64_tr_b16 v[44:45], v5 offset:36864
    v_mfma_f32_16x16x32_bf16 v[60:63], v[48:51], v[212:215], v[60:63]
    ds_read_b64_tr_b16 v[46:47], v5 offset:37376
    s_waitcnt lgkmcnt(2)
    v_mfma_f32_16x16x32_bf16 v[56:59], v[52:55], v[144:147], v[56:59]
    ds_read_b64_tr_b16 v[48:49], v5 offset:40960
    v_mfma_f32_16x16x32_bf16 v[60:63], v[52:55], v[216:219], v[60:63]
    s_add_u32 m0, s41, 8192
    ds_read_b64_tr_b16 v[50:51], v5 offset:41472
    buffer_load_dwordx4 v22, s[16:19], s37 offen  lds
    s_waitcnt lgkmcnt(2)
    v_mfma_f32_16x16x32_bf16 v[56:59], v[44:47], v[148:151], v[56:59]
    ds_read_b64_tr_b16 v[52:53], v5 offset:45056
    v_mfma_f32_16x16x32_bf16 v[60:63], v[44:47], v[220:223], v[60:63]
    ds_read_b64_tr_b16 v[54:55], v5 offset:45568
    s_waitcnt lgkmcnt(2)
    v_mfma_f32_16x16x32_bf16 v[56:59], v[48:51], v[152:155], v[56:59]
    ds_read_b64_tr_b16 v[44:45], v6 offset:0
    v_mfma_f32_16x16x32_bf16 v[60:63], v[48:51], v[224:227], v[60:63]
    s_add_u32 m0, s41, 16384
    ds_read_b64_tr_b16 v[46:47], v6 offset:512
    buffer_load_dwordx4 v23, s[16:19], s37 offen  lds
    s_add_u32 s37, s37, s38
    s_waitcnt lgkmcnt(2)
    v_mfma_f32_16x16x32_bf16 v[56:59], v[52:55], v[156:159], v[56:59]
    ds_read_b64_tr_b16 v[48:49], v6 offset:4096
    v_mfma_f32_16x16x32_bf16 v[60:63], v[52:55], v[228:231], v[60:63]
    ds_read_b64_tr_b16 v[50:51], v6 offset:4608
    s_waitcnt vmcnt(9)
    s_barrier
    s_waitcnt lgkmcnt(2)
    v_mfma_f32_16x16x32_bf16 v[56:59], v[44:47], v[160:163], v[56:59]
    ds_read_b64_tr_b16 v[52:53], v6 offset:8192
    v_mfma_f32_16x16x32_bf16 v[60:63], v[44:47], v[232:235], v[60:63]
    s_add_u32 m0, s41, 24576
    ds_read_b64_tr_b16 v[54:55], v6 offset:8704
    buffer_load_dwordx4 v3, s[16:19], s37 offen  lds
    s_waitcnt lgkmcnt(2)
    v_mfma_f32_16x16x32_bf16 v[56:59], v[48:51], v[164:167], v[56:59]
    ds_read_b64_tr_b16 v[44:45], v6 offset:12288
    v_mfma_f32_16x16x32_bf16 v[60:63], v[48:51], v[236:239], v[60:63]
    ds_read_b64_tr_b16 v[46:47], v6 offset:12800
    s_waitcnt lgkmcnt(2)
    v_mfma_f32_16x16x32_bf16 v[56:59], v[52:55], v[168:171], v[56:59]
    ds_read_b64_tr_b16 v[48:49], v6 offset:16384
    v_mfma_f32_16x16x32_bf16 v[60:63], v[52:55], v[240:243], v[60:63]
    s_add_u32 m0, s41, 32768
    ds_read_b64_tr_b16 v[50:51], v6 offset:16896
    buffer_load_dwordx4 v22, s[16:19], s37 offen  lds
    s_waitcnt lgkmcnt(2)
    v_mfma_f32_16x16x32_bf16 v[56:59], v[44:47], v[172:175], v[56:59]
    ds_read_b64_tr_b16 v[52:53], v6 offset:20480
    v_mfma_f32_16x16x32_bf16 v[60:63], v[44:47], v[244:247], v[60:63]
    ds_read_b64_tr_b16 v[54:55], v6 offset:20992
    s_waitcnt lgkmcnt(2)
    v_mfma_f32_16x16x32_bf16 v[56:59], v[48:51], v[176:179], v[56:59]
    ds_read_b64_tr_b16 v[44:45], v6 offset:24576
    v_mfma_f32_16x16x32_bf16 v[60:63], v[48:51], v[248:251], v[60:63]
    s_add_u32 m0, s41, 40960
    ds_read_b64_tr_b16 v[46:47], v6 offset:25088
    buffer_load_dwordx4 v23, s[16:19], s37 offen  lds
    s_add_u32 s37, s37, s38
    s_waitcnt lgkmcnt(2)
    v_mfma_f32_16x16x32_bf16 v[56:59], v[52:55], v[180:183], v[56:59]
    ds_read_b64_tr_b16 v[48:49], v6 offset:28672
    v_mfma_f32_16x16x32_bf16 v[60:63], v[52:55], v[252:255], v[60:63]
    ds_read_b64_tr_b16 v[50:51], v6 offset:29184
    s_waitcnt vmcnt(9)
    s_barrier
    s_waitcnt lgkmcnt(2)
    v_mfma_f32_16x16x32_bf16 v[64:67], v[44:47], v[112:115], 0
    ds_read_b64_tr_b16 v[52:53], v6 offset:32768
    v_mfma_f32_16x16x32_bf16 v[68:71], v[44:47], v[184:187], 0
    s_add_u32 m0, s41, 49152
    ds_read_b64_tr_b16 v[54:55], v6 offset:33280
    buffer_load_dwordx4 v3, s[16:19], s37 offen  lds
    s_waitcnt lgkmcnt(2)
    v_mfma_f32_16x16x32_bf16 v[64:67], v[48:51], v[116:119], v[64:67]
    ds_read_b64_tr_b16 v[44:45], v6 offset:36864
    v_cvt_pk_bf16_f32 v40, v56, v57
    v_mfma_f32_16x16x32_bf16 v[68:71], v[48:51], v[188:191], v[68:71]
    ds_read_b64_tr_b16 v[46:47], v6 offset:37376
    v_cvt_pk_bf16_f32 v41, v58, v59
    s_waitcnt lgkmcnt(2)
    v_mfma_f32_16x16x32_bf16 v[64:67], v[52:55], v[120:123], v[64:67]
    ds_read_b64_tr_b16 v[48:49], v6 offset:40960
    v_mfma_f32_16x16x32_bf16 v[68:71], v[52:55], v[192:195], v[68:71]
    s_add_u32 m0, s41, 57344
    ds_read_b64_tr_b16 v[50:51], v6 offset:41472
    buffer_load_dwordx4 v22, s[16:19], s37 offen  lds
    v_cvt_pk_bf16_f32 v42, v60, v61
    s_waitcnt lgkmcnt(2)
    v_mfma_f32_16x16x32_bf16 v[64:67], v[44:47], v[124:127], v[64:67]
    ds_read_b64_tr_b16 v[52:53], v6 offset:45056
    v_cvt_pk_bf16_f32 v43, v62, v63
    v_mfma_f32_16x16x32_bf16 v[68:71], v[44:47], v[196:199], v[68:71]
    ds_read_b64_tr_b16 v[54:55], v6 offset:45568
    buffer_store_dwordx4 v[40:43], v9, s[4:7], s43 offen sc1
    s_mov_b32 s43, s44
    s_add_u32 s59, s59, 1
    s_add_u32 s44, s59, s35
    s_and_b32 s44, s44, 7
    s_lshl_b32 s44, s44, 13
    s_add_u32 s44, s44, s32
    s_waitcnt lgkmcnt(2)
    v_mfma_f32_16x16x32_bf16 v[64:67], v[48:51], v[128:131], v[64:67]
    ds_read_b64_tr_b16 v[44:45], v7 offset:0
    v_mfma_f32_16x16x32_bf16 v[68:71], v[48:51], v[200:203], v[68:71]
    s_add_u32 m0, s41, 65536
    ds_read_b64_tr_b16 v[46:47], v7 offset:512
    buffer_load_dwordx4 v23, s[16:19], s37 offen  lds
    s_add_u32 s63, s63, 1
    s_add_u32 s42, s63, s60
    s_and_b32 s42, s42, s61
    s_lshl_b32 s42, s42, 7
    s_add_u32 s37, s62, s42
    s_waitcnt lgkmcnt(2)
    v_mfma_f32_16x16x32_bf16 v[64:67], v[52:55], v[132:135], v[64:67]
    ds_read_b64_tr_b16 v[48:49], v7 offset:4096
    v_mfma_f32_16x16x32_bf16 v[68:71], v[52:55], v[204:207], v[68:71]
    ds_read_b64_tr_b16 v[50:51], v7 offset:4608
    s_waitcnt vmcnt(9)
    s_barrier
    s_waitcnt lgkmcnt(2)
    v_mfma_f32_16x16x32_bf16 v[64:67], v[44:47], v[136:139], v[64:67]
    ds_read_b64_tr_b16 v[52:53], v7 offset:8192
    v_mfma_f32_16x16x32_bf16 v[68:71], v[44:47], v[208:211], v[68:71]
    s_add_u32 m0, s41, 73728
    ds_read_b64_tr_b16 v[54:55], v7 offset:8704
    buffer_load_dwordx4 v3, s[16:19], s37 offen  lds
    s_waitcnt lgkmcnt(2)
    v_mfma_f32_16x16x32_bf16 v[64:67], v[48:51], v[140:143], v[64:67]
    ds_read_b64_tr_b16 v[44:45], v7 offset:12288
    v_mfma_f32_16x16x32_bf16 v[68:71], v[48:51], v[212:215], v[68:71]
    ds_read_b64_tr_b16 v[46:47], v7 offset:12800
    s_waitcnt lgkmcnt(2)
    v_mfma_f32_16x16x32_bf16 v[64:67], v[52:55], v[144:147], v[64:67]
    ds_read_b64_tr_b16 v[48:49], v7 offset:16384
    v_mfma_f32_16x16x32_bf16 v[68:71], v[52:55], v[216:219], v[68:71]
    s_add_u32 m0, s41, 81920
    ds_read_b64_tr_b16 v[50:51], v7 offset:16896
    buffer_load_dwordx4 v22, s[16:19], s37 offen  lds
    s_waitcnt lgkmcnt(2)
    v_mfma_f32_16x16x32_bf16 v[64:67], v[44:47], v[148:151], v[64:67]
    ds_read_b64_tr_b16 v[52:53], v7 offset:20480
    v_mfma_f32_16x16x32_bf16 v[68:71], v[44:47], v[220:223], v[68:71]
    ds_read_b64_tr_b16 v[54:55], v7 offset:20992
    s_waitcnt lgkmcnt(2)
    v_mfma_f32_16x16x32_bf16 v[64:67], v[48:51], v[152:155], v[64:67]
    ds_read_b64_tr_b16 v[44:45], v7 offset:24576
    v_mfma_f32_16x16x32_bf16 v[68:71], v[48:51], v[224:227], v[68:71]
    s_add_u32 m0, s41, 90112
    ds_read_b64_tr_b16 v[46:47], v7 offset:25088
    buffer_load_dwordx4 v23, s[16:19], s37 offen  lds
    s_add_u32 s37, s37, s38
    s_waitcnt lgkmcnt(2)
    v_mfma_f32_16x16x32_bf16 v[64:67], v[52:55], v[156:159], v[64:67]
    ds_read_b64_tr_b16 v[48:49], v7 offset:28672
    v_mfma_f32_16x16x32_bf16 v[68:71], v[52:55], v[228:231], v[68:71]
    ds_read_b64_tr_b16 v[50:51], v7 offset:29184
    s_waitcnt vmcnt(9)
    s_barrier
    s_waitcnt lgkmcnt(2)
    v_mfma_f32_16x16x32_bf16 v[64:67], v[44:47], v[160:163], v[64:67]
    ds_read_b64_tr_b16 v[52:53], v7 offset:32768
    v_mfma_f32_16x16x32_bf16 v[68:71], v[44:47], v[232:235], v[68:71]
    s_add_u32 m0, s41, 98304
    ds_read_b64_tr_b16 v[54:55], v7 offset:33280
    buffer_load_dwordx4 v3, s[16:19], s37 offen  lds
    s_waitcnt lgkmcnt(2)
    v_mfma_f32_16x16x32_bf16 v[64:67], v[48:51], v[164:167], v[64:67]
    ds_read_b64_tr_b16 v[44:45], v7 offset:36864
    v_mfma_f32_16x16x32_bf16 v[68:71], v[48:51], v[236:239], v[68:71]
    ds_read_b64_tr_b16 v[46:47], v7 offset:37376
    s_waitcnt lgkmcnt(2)
    v_mfma_f32_16x16x32_bf16 v[64:67], v[52:55], v[168:171], v[64:67]
    ds_read_b64_tr_b16 v[48:49], v7 offset:40960
    v_mfma_f32_16x16x32_bf16 v[68:71], v[52:55], v[240:243], v[68:71]
    s_add_u32 m0, s41, 106496
    ds_read_b64_tr_b16 v[50:51], v7 offset:41472
    buffer_load_dwordx4 v22, s[16:19], s37 offen  lds
    s_waitcnt lgkmcnt(2)
    v_mfma_f32_16x16x32_bf16 v[64:67], v[44:47], v[172:175], v[64:67]
    ds_read_b64_tr_b16 v[52:53], v7 offset:45056
    v_mfma_f32_16x16x32_bf16 v[68:71], v[44:47], v[244:247], v[68:71]
    ds_read_b64_tr_b16 v[54:55], v7 offset:45568
    s_waitcnt lgkmcnt(2)
    v_mfma_f32_16x16x32_bf16 v[64:67], v[48:51], v[176:179], v[64:67]
    ds_read_b64_tr_b16 v[44:45], v5 offset:0
    v_mfma_f32_16x16x32_bf16 v[68:71], v[48:51], v[248:251], v[68:71]
    s_add_u32 m0, s41, 114688
    ds_read_b64_tr_b16 v[46:47], v5 offset:512
    buffer_load_dwordx4 v23, s[16:19], s37 offen  lds
    s_add_u32 s37, s37, s38
    s_waitcnt lgkmcnt(2)
    v_mfma_f32_16x16x32_bf16 v[64:67], v[52:55], v[180:183], v[64:67]
    ds_read_b64_tr_b16 v[48:49], v5 offset:4096
    v_mfma_f32_16x16x32_bf16 v[68:71], v[52:55], v[252:255], v[68:71]
    ds_read_b64_tr_b16 v[50:51], v5 offset:4608
    s_add_u32 s45, s45, 8
    s_add_u32 s36, s36, 1
    s_cmp_lt_u32 s36, 3
    s_cbranch_scc1 L_p2_0
    s_waitcnt vmcnt(9)
    s_barrier
    s_waitcnt lgkmcnt(2)
    v_mfma_f32_16x16x32_bf16 v[56:59], v[44:47], v[112:115], 0
    ds_read_b64_tr_b16 v[52:53], v5 offset:8192
    v_mfma_f32_16x16x32_bf16 v[60:63], v[44:47], v[184:187], 0
    s_add_u32 m0, s41, 122880
    ds_read_b64_tr_b16 v[54:55], v5 offset:8704
    buffer_load_dwordx4 v3, s[16:19], s37 offen  lds
    s_waitcnt lgkmcnt(2)
    v_mfma_f32_16x16x32_bf16 v[56:59], v[48:51], v[116:119], v[56:59]
    ds_read_b64_tr_b16 v[44:45], v5 offset:12288
    v_cvt_pk_bf16_f32 v40, v64, v65
    v_mfma_f32_16x16x32_bf16 v[60:63], v[48:51], v[188:191], v[60:63]
    ds_read_b64_tr_b16 v[46:47], v5 offset:12800
    v_cvt_pk_bf16_f32 v41, v66, v67
    s_waitcnt lgkmcnt(2)
    v_mfma_f32_16x16x32_bf16 v[56:59], v[52:55], v[120:123], v[56:59]
    ds_read_b64_tr_b16 v[48:49], v5 offset:16384
    v_mfma_f32_16x16x32_bf16 v[60:63], v[52:55], v[192:195], v[60:63]
    s_add_u32 m0, s41, 131072
    ds_read_b64_tr_b16 v[50:51], v5 offset:16896
    buffer_load_dwordx4 v22, s[16:19], s37 offen  lds
    v_cvt_pk_bf16_f32 v42, v68, v69
    s_waitcnt lgkmcnt(2)
    v_mfma_f32_16x16x32_bf16 v[56:59], v[44:47], v[124:127], v[56:59]
    ds_read_b64_tr_b16 v[52:53], v5 offset:20480
    v_cvt_pk_bf16_f32 v43, v70, v71
    v_mfma_f32_16x16x32_bf16 v[60:63], v[44:47], v[196:199], v[60:63]
    ds_read_b64_tr_b16 v[54:55], v5 offset:20992
    buffer_store_dwordx4 v[40:43], v9, s[4:7], s43 offen sc1
    s_mov_b32 s43, s44
    s_add_u32 s59, s59, 1
    s_add_u32 s44, s59, s35
    s_and_b32 s44, s44, 7
    s_lshl_b32 s44, s44, 13
    s_add_u32 s44, s44, s32
    s_waitcnt lgkmcnt(2)
    v_mfma_f32_16x16x32_bf16 v[56:59], v[48:51], v[128:131], v[56:59]
    ds_read_b64_tr_b16 v[44:45], v5 offset:24576
    v_mfma_f32_16x16x32_bf16 v[60:63], v[48:51], v[200:203], v[60:63]
    s_add_u32 m0, s41, 139264
    ds_read_b64_tr_b16 v[46:47], v5 offset:25088
    buffer_load_dwordx4 v23, s[16:19], s37 offen  lds
    s_add_u32 s63, s63, 1
    s_add_u32 s42, s63, s60
    s_and_b32 s42, s42, s61
    s_lshl_b32 s42, s42, 7
    s_add_u32 s37, s62, s42
    s_waitcnt lgkmcnt(2)
    v_mfma_f32_16x16x32_bf16 v[56:59], v[52:55], v[132:135], v[56:59]
    ds_read_b64_tr_b16 v[48:49], v5 offset:28672
    v_mfma_f32_16x16x32_bf16 v[60:63], v[52:55], v[204:207], v[60:63]
    ds_read_b64_tr_b16 v[50:51], v5 offset:29184
    s_waitcnt vmcnt(9)
    s_barrier
    s_waitcnt lgkmcnt(2)
    v_mfma_f32_16x16x32_bf16 v[56:59], v[44:47], v[136:139], v[56:59]
    ds_read_b64_tr_b16 v[52:53], v5 offset:32768
    v_mfma_f32_16x16x32_bf16 v[60:63], v[44:47], v[208:211], v[60:63]
    s_add_u32 m0, s41, 0
    ds_read_b64_tr_b16 v[54:55], v5 offset:33280
    buffer_load_dwordx4 v3, s[16:19], s37 offen  lds
    s_waitcnt lgkmcnt(2)
    v_mfma_f32_16x16x32_bf16 v[56:59], v[48:51], v[140:143], v[56:59]
    ds_read_b64_tr_b16 v[44:45], v5 offset:36864
    v_mfma_f32_16x16x32_bf16 v[60:63], v[48:51], v[212:215], v[60:63]
    ds_read_b64_tr_b16 v[46:47], v5 offset:37376
    s_waitcnt lgkmcnt(2)
    v_mfma_f32_16x16x32_bf16 v[56:59], v[52:55], v[144:147], v[56:59]
    ds_read_b64_tr_b16 v[48:49], v5 offset:40960
    v_mfma_f32_16x16x32_bf16 v[60:63], v[52:55], v[216:219], v[60:63]
    s_add_u32 m0, s41, 8192
    ds_read_b64_tr_b16 v[50:51], v5 offset:41472
    buffer_load_dwordx4 v22, s[16:19], s37 offen  lds
    s_waitcnt lgkmcnt(2)
    v_mfma_f32_16x16x32_bf16 v[56:59], v[44:47], v[148:151], v[56:59]
    ds_read_b64_tr_b16 v[52:53], v5 offset:45056
    v_mfma_f32_16x16x32_bf16 v[60:63], v[44:47], v[220:223], v[60:63]
    ds_read_b64_tr_b16 v[54:55], v5 offset:45568
    buffer_load_dword v2, v12, s[4:7], s46 offen sc1
    s_waitcnt lgkmcnt(2)
    v_mfma_f32_16x16x32_bf16 v[56:59], v[48:51], v[152:155], v[56:59]
    ds_read_b64_tr_b16 v[44:45], v6 offset:0
    v_mfma_f32_16x16x32_bf16 v[60:63], v[48:51], v[224:227], v[60:63]
    s_add_u32 m0, s41, 16384
    ds_read_b64_tr_b16 v[46:47], v6 offset:512
    buffer_load_dwordx4 v23, s[16:19], s37 offen  lds
    s_add_u32 s37, s37, s38
    s_waitcnt lgkmcnt(2)
    v_mfma_f32_16x16x32_bf16 v[56:59], v[52:55], v[156:159], v[56:59]
    ds_read_b64_tr_b16 v[48:49], v6 offset:4096
    v_mfma_f32_16x16x32_bf16 v[60:63], v[52:55], v[228:231], v[60:63]
    ds_read_b64_tr_b16 v[50:51], v6 offset:4608
    s_waitcnt vmcnt(9)
    s_barrier
    s_waitcnt lgkmcnt(2)
    v_mfma_f32_16x16x32_bf16 v[56:59], v[44:47], v[160:163], v[56:59]
    ds_read_b64_tr_b16 v[52:53], v6 offset:8192
    v_mfma_f32_16x16x32_bf16 v[60:63], v[44:47], v[232:235], v[60:63]
    s_add_u32 m0, s41, 24576
    ds_read_b64_tr_b16 v[54:55], v6 offset:8704
    buffer_load_dwordx4 v3, s[16:19], s37 offen  lds
    s_waitcnt lgkmcnt(2)
    v_mfma_f32_16x16x32_bf16 v[56:59], v[48:51], v[164:167], v[56:59]
    ds_read_b64_tr_b16 v[44:45], v6 offset:12288
    v_mfma_f32_16x16x32_bf16 v[60:63], v[48:51], v[236:239], v[60:63]
    ds_read_b64_tr_b16 v[46:47], v6 offset:12800
    s_waitcnt lgkmcnt(2)
    v_mfma_f32_16x16x32_bf16 v[56:59], v[52:55], v[168:171], v[56:59]
    ds_read_b64_tr_b16 v[48:49], v6 offset:16384
    v_mfma_f32_16x16x32_bf16 v[60:63], v[52:55], v[240:243], v[60:63]
    s_add_u32 m0, s41, 32768
    ds_read_b64_tr_b16 v[50:51], v6 offset:16896
    buffer_load_dwordx4 v22, s[16:19], s37 offen  lds
    s_mul_i32 s52, s34, 73728
    s_lshl_b32 s54, s53, 11
    s_add_u32 s52, s52, s54
    s_add_u32 s52, s52, 7667712
    s_mov_b32 m0, 155648
    s_nop 0
    buffer_load_dwordx4 v19, s[4:7], s52 offen lds
    s_mov_b32 s52, 7480064
    v_lshlrev_b32 v16, 2, v21
    buffer_load_dwordx4 v[104:107], v16, s[4:7], s52 offen
    s_mov_b32 s54, 1024
    v_lshlrev_b32 v17, 1, v21
    buffer_load_dwordx2 v[10:11], v17, s[8:11], s54 offen
    s_waitcnt lgkmcnt(2)
    v_mfma_f32_16x16x32_bf16 v[56:59], v[44:47], v[172:175], v[56:59]
    ds_read_b64_tr_b16 v[52:53], v6 offset:20480
    v_mfma_f32_16x16x32_bf16 v[60:63], v[44:47], v[244:247], v[60:63]
    ds_read_b64_tr_b16 v[54:55], v6 offset:20992
    s_waitcnt lgkmcnt(2)
    v_mfma_f32_16x16x32_bf16 v[56:59], v[48:51], v[176:179], v[56:59]
    ds_read_b64_tr_b16 v[44:45], v6 offset:24576
    v_mfma_f32_16x16x32_bf16 v[60:63], v[48:51], v[248:251], v[60:63]
    s_add_u32 m0, s41, 40960
    ds_read_b64_tr_b16 v[46:47], v6 offset:25088
    buffer_load_dwordx4 v23, s[16:19], s37 offen  lds
    s_add_u32 s37, s37, s38
    s_waitcnt lgkmcnt(2)
    v_mfma_f32_16x16x32_bf16 v[56:59], v[52:55], v[180:183], v[56:59]
    ds_read_b64_tr_b16 v[48:49], v6 offset:28672
    v_mfma_f32_16x16x32_bf16 v[60:63], v[52:55], v[252:255], v[60:63]
    ds_read_b64_tr_b16 v[50:51], v6 offset:29184
    s_waitcnt vmcnt(9)
    s_barrier
    s_cmp_eq_u32 s33, 0
    s_cbranch_scc0 L_sigb
    s_lshl_b32 s52, s35, 2
    s_add_u32 s52, s52, s46
    v_mov_b32 v16, 2
    v_mov_b32 v17, 0
    s_mov_b64 exec, 1
    buffer_store_dword v16, v17, s[4:7], s52 offen sc1
    s_mov_b64 exec, -1
L_sigb:
    s_waitcnt lgkmcnt(2)
    v_mfma_f32_16x16x32_bf16 v[64:67], v[44:47], v[112:115], 0
    ds_read_b64_tr_b16 v[52:53], v6 offset:32768
    v_mfma_f32_16x16x32_bf16 v[68:71], v[44:47], v[184:187], 0
    s_add_u32 m0, s41, 49152
    ds_read_b64_tr_b16 v[54:55], v6 offset:33280
    buffer_load_dwordx4 v3, s[16:19], s37 offen  lds
    s_waitcnt lgkmcnt(2)
    v_mfma_f32_16x16x32_bf16 v[64:67], v[48:51], v[116:119], v[64:67]
    ds_read_b64_tr_b16 v[44:45], v6 offset:36864
    v_cvt_pk_bf16_f32 v40, v56, v57
    v_mfma_f32_16x16x32_bf16 v[68:71], v[48:51], v[188:191], v[68:71]
    ds_read_b64_tr_b16 v[46:47], v6 offset:37376
    v_cvt_pk_bf16_f32 v41, v58, v59
    s_waitcnt lgkmcnt(2)
    v_mfma_f32_16x16x32_bf16 v[64:67], v[52:55], v[120:123], v[64:67]
    ds_read_b64_tr_b16 v[48:49], v6 offset:40960
    v_mfma_f32_16x16x32_bf16 v[68:71], v[52:55], v[192:195], v[68:71]
    s_add_u32 m0, s41, 57344
    ds_read_b64_tr_b16 v[50:51], v6 offset:41472
    buffer_load_dwordx4 v22, s[16:19], s37 offen  lds
    v_cvt_pk_bf16_f32 v42, v60, v61
    s_waitcnt lgkmcnt(2)
    v_mfma_f32_16x16x32_bf16 v[64:67], v[44:47], v[124:127], v[64:67]
    ds_read_b64_tr_b16 v[52:53], v6 offset:45056
    v_cvt_pk_bf16_f32 v43, v62, v63
    v_mfma_f32_16x16x32_bf16 v[68:71], v[44:47], v[196:199], v[68:71]
    ds_read_b64_tr_b16 v[54:55], v6 offset:45568
    buffer_store_dwordx4 v[40:43], v9, s[4:7], s43 offen sc1
    s_mov_b32 s43, s44
    s_add_u32 s59, s59, 1
    s_add_u32 s44, s59, s35
    s_and_b32 s44, s44, 7
    s_lshl_b32 s44, s44, 13
    s_add_u32 s44, s44, s32
    s_waitcnt lgkmcnt(2)
    v_mfma_f32_16x16x32_bf16 v[64:67], v[48:51], v[128:131], v[64:67]
    ds_read_b64_tr_b16 v[44:45], v7 offset:0
    v_mfma_f32_16x16x32_bf16 v[68:71], v[48:51], v[200:203], v[68:71]
    s_add_u32 m0, s41, 65536
    ds_read_b64_tr_b16 v[46:47], v7 offset:512
    buffer_load_dwordx4 v23, s[16:19], s37 offen  lds
    s_add_u32 s63, s63, 1
    s_add_u32 s42, s63, s60
    s_and_b32 s42, s42, s61
    s_lshl_b32 s42, s42, 7
    s_add_u32 s37, s62, s42
    s_waitcnt lgkmcnt(2)
    v_mfma_f32_16x16x32_bf16 v[64:67], v[52:55], v[132:135], v[64:67]
    ds_read_b64_tr_b16 v[48:49], v7 offset:4096
    v_mfma_f32_16x16x32_bf16 v[68:71], v[52:55], v[204:207], v[68:71]
    ds_read_b64_tr_b16 v[50:51], v7 offset:4608
    s_waitcnt vmcnt(9)
    s_barrier
    s_waitcnt lgkmcnt(2)
    v_mfma_f32_16x16x32_bf16 v[64:67], v[44:47], v[136:139], v[64:67]
    ds_read_b64_tr_b16 v[52:53], v7 offset:8192
    v_mfma_f32_16x16x32_bf16 v[68:71], v[44:47], v[208:211], v[68:71]
    ds_read_b64_tr_b16 v[54:55], v7 offset:8704
    s_mov_b32 s51, 0x40000
L_spina:
    v_cmp_gt_u32 vcc, 1, v2
    s_nop 4
    s_cbranch_vccz L_spuna
    s_sub_u32 s51, s51, 1
    s_cmp_eq_u32 s51, 0
    s_cbranch_scc1 L_spuna
    s_sleep 1
    buffer_load_dword v2, v12, s[4:7], s46 offen sc1
    s_waitcnt vmcnt(0)
    s_branch L_spina
L_spuna:
    s_mul_i32 s52, s34, 589824
    s_mul_i32 s54, s33, 73728
    s_add_u32 s52, s52, s54
    s_lshl_b32 s54, s35, 10
    s_add_u32 s52, s52, s54
    s_add_u32 s52, s52, 12648448
    buffer_load_dwordx4 v[100:103], v13, s[4:7], s52 offen sc1
    s_waitcnt lgkmcnt(2)
    v_mfma_f32_16x16x32_bf16 v[64:67], v[48:51], v[140:143], v[64:67]
    ds_read_b64_tr_b16 v[44:45], v7 offset:12288
    v_mfma_f32_16x16x32_bf16 v[68:71], v[48:51], v[212:215], v[68:71]
    ds_read_b64_tr_b16 v[46:47], v7 offset:12800
    s_waitcnt lgkmcnt(2)
    v_mfma_f32_16x16x32_bf16 v[64:67], v[52:55], v[144:147], v[64:67]
    ds_read_b64_tr_b16 v[48:49], v7 offset:16384
    v_mfma_f32_16x16x32_bf16 v[68:71], v[52:55], v[216:219], v[68:71]
    ds_read_b64_tr_b16 v[50:51], v7 offset:16896
    s_waitcnt lgkmcnt(2)
    v_mfma_f32_16x16x32_bf16 v[64:67], v[44:47], v[148:151], v[64:67]
    ds_read_b64_tr_b16 v[52:53], v7 offset:20480
    v_mfma_f32_16x16x32_bf16 v[68:71], v[44:47], v[220:223], v[68:71]
    ds_read_b64_tr_b16 v[54:55], v7 offset:20992
    s_waitcnt lgkmcnt(2)
    v_mfma_f32_16x16x32_bf16 v[64:67], v[48:51], v[152:155], v[64:67]
    ds_read_b64_tr_b16 v[44:45], v7 offset:24576
    v_mfma_f32_16x16x32_bf16 v[68:71], v[48:51], v[224:227], v[68:71]
    ds_read_b64_tr_b16 v[46:47], v7 offset:25088
    s_waitcnt lgkmcnt(2)
    v_mfma_f32_16x16x32_bf16 v[64:67], v[52:55], v[156:159], v[64:67]
    ds_read_b64_tr_b16 v[48:49], v7 offset:28672
    v_mfma_f32_16x16x32_bf16 v[68:71], v[52:55], v[228:231], v[68:71]
    ds_read_b64_tr_b16 v[50:51], v7 offset:29184
    s_waitcnt vmcnt(9)
    s_barrier
    s_waitcnt lgkmcnt(2)
    v_mfma_f32_16x16x32_bf16 v[64:67], v[44:47], v[160:163], v[64:67]
    ds_read_b64_tr_b16 v[52:53], v7 offset:32768
    v_mfma_f32_16x16x32_bf16 v[68:71], v[44:47], v[232:235], v[68:71]
    ds_read_b64_tr_b16 v[54:55], v7 offset:33280
    buffer_load_dword v2, v12, s[4:7], s46 offen sc1
    s_waitcnt lgkmcnt(2)
    v_mfma_f32_16x16x32_bf16 v[64:67], v[48:51], v[164:167], v[64:67]
    ds_read_b64_tr_b16 v[44:45], v7 offset:36864
    v_mfma_f32_16x16x32_bf16 v[68:71], v[48:51], v[236:239], v[68:71]
    ds_read_b64_tr_b16 v[46:47], v7 offset:37376
    s_waitcnt lgkmcnt(2)
    v_mfma_f32_16x16x32_bf16 v[64:67], v[52:55], v[168:171], v[64:67]
    ds_read_b64_tr_b16 v[48:49], v7 offset:40960
    v_mfma_f32_16x16x32_bf16 v[68:71], v[52:55], v[240:243], v[68:71]
    ds_read_b64_tr_b16 v[50:51], v7 offset:41472
    s_waitcnt lgkmcnt(2)
    v_mfma_f32_16x16x32_bf16 v[64:67], v[44:47], v[172:175], v[64:67]
    ds_read_b64_tr_b16 v[52:53], v7 offset:45056
    v_mfma_f32_16x16x32_bf16 v[68:71], v[44:47], v[244:247], v[68:71]
    ds_read_b64_tr_b16 v[54:55], v7 offset:45568
    s_waitcnt lgkmcnt(2)
    v_mfma_f32_16x16x32_bf16 v[64:67], v[48:51], v[176:179], v[64:67]
    ds_read_b64_tr_b16 v[44:45], v5 offset:0
    v_mfma_f32_16x16x32_bf16 v[68:71], v[48:51], v[248:251], v[68:71]
    ds_read_b64_tr_b16 v[46:47], v5 offset:512
    s_waitcnt lgkmcnt(2)
    v_mfma_f32_16x16x32_bf16 v[64:67], v[52:55], v[180:183], v[64:67]
    ds_read_b64_tr_b16 v[48:49], v5 offset:4096
    v_mfma_f32_16x16x32_bf16 v[68:71], v[52:55], v[252:255], v[68:71]
    ds_read_b64_tr_b16 v[50:51], v5 offset:4608
    s_waitcnt vmcnt(2)
    s_barrier
    s_waitcnt lgkmcnt(2)
    v_mfma_f32_16x16x32_bf16 v[56:59], v[44:47], v[112:115], 0
    ds_read_b64_tr_b16 v[52:53], v5 offset:8192
    v_mfma_f32_16x16x32_bf16 v[60:63], v[44:47], v[184:187], 0
    ds_read_b64_tr_b16 v[54:55], v5 offset:8704
    s_waitcnt lgkmcnt(2)
    v_mfma_f32_16x16x32_bf16 v[56:59], v[48:51], v[116:119], v[56:59]
    ds_read_b64_tr_b16 v[44:45], v5 offset:12288
    v_cvt_pk_bf16_f32 v40, v64, v65
    v_cvt_pk_bf16_f32 v41, v66, v67
    v_mfma_f32_16x16x32_bf16 v[60:63], v[48:51], v[188:191], v[60:63]
    ds_read_b64_tr_b16 v[46:47], v5 offset:12800
    v_cvt_pk_bf16_f32 v42, v68, v69
    v_cvt_pk_bf16_f32 v43, v70, v71
    buffer_store_dwordx4 v[40:43], v9, s[4:7], s43 offen sc1
    s_mov_b32 s43, s44
    s_add_u32 s59, s59, 1
    s_add_u32 s44, s59, s35
    s_and_b32 s44, s44, 7
    s_lshl_b32 s44, s44, 13
    s_add_u32 s44, s44, s32
    s_waitcnt vmcnt(2)
    s_lshl_b32 s54, s33, 10
    s_add_u32 s54, s54, 73728
    v_add_u32 v16, s54, v13
    ds_write_b128 v16, v[100:103]
    s_waitcnt lgkmcnt(3)
    v_mfma_f32_16x16x32_bf16 v[56:59], v[52:55], v[120:123], v[56:59]
    ds_read_b64_tr_b16 v[48:49], v5 offset:16384
    v_mfma_f32_16x16x32_bf16 v[60:63], v[52:55], v[192:195], v[60:63]
    ds_read_b64_tr_b16 v[50:51], v5 offset:16896
    s_waitcnt lgkmcnt(3)
    v_mfma_f32_16x16x32_bf16 v[56:59], v[44:47], v[124:127], v[56:59]
    ds_read_b64_tr_b16 v[52:53], v5 offset:20480
    v_mfma_f32_16x16x32_bf16 v[60:63], v[44:47], v[196:199], v[60:63]
    ds_read_b64_tr_b16 v[54:55], v5 offset:20992
    s_waitcnt lgkmcnt(2)
    v_mfma_f32_16x16x32_bf16 v[56:59], v[48:51], v[128:131], v[56:59]
    ds_read_b64_tr_b16 v[44:45], v5 offset:24576
    v_mfma_f32_16x16x32_bf16 v[60:63], v[48:51], v[200:203], v[60:63]
    ds_read_b64_tr_b16 v[46:47], v5 offset:25088
    s_waitcnt vmcnt(1)
    s_mov_b32 s51, 0x40000
L_spinb:
    v_cmp_gt_u32 vcc, 2, v2
    s_nop 4
    s_cbranch_vccz L_spunb
    s_sub_u32 s51, s51, 1
    s_cmp_eq_u32 s51, 0
    s_cbranch_scc1 L_spunb
    s_sleep 1
    buffer_load_dword v2, v12, s[4:7], s46 offen sc1
    s_waitcnt vmcnt(0)
    s_branch L_spinb
L_spunb:
    v_mov_b32 v3, v8
    s_lshr_b32 s52, s33, 2
    s_and_b32 s53, s33, 3
    s_mov_b32 s50, s35
    s_lshl_b32 s54, s34, 6
    s_lshl_b32 s55, s52, 5
    s_add_u32 s54, s54, s55
    v_add_u32 v8, s54, v14
    v_mul_u32_u24 v8, 1152, v8
    s_lshl_b32 s55, s53, 4
    v_lshlrev_b32 v21, 2, v15
    v_add_u32 v21, s55, v21
    v_lshlrev_b32 v16, 1, v21
    v_add_u32 v8, v8, v16
    v_lshrrev_b32 v19, 2, v1
    v_lshlrev_b32 v19, 7, v19
    v_and_b32 v16, 3, v1
    v_lshlrev_b32 v16, 4, v16
    v_add_u32 v19, v19, v16
    s_lshl_b32 s55, s52, 6
    v_add_u32 v19, s55, v19
    s_mul_i32 s52, s34, 73728
    s_lshl_b32 s54, s50, 13
    s_add_u32 s52, s52, s54
    s_lshl_b32 s54, s53, 11
    s_add_u32 s52, s52, s54
    s_add_u32 s52, s52, 7602176
    s_lshl_b32 s54, s33, 10
    s_add_u32 m0, s54, 147456
    s_nop 0
    buffer_load_dwordx4 v19, s[4:7], s52 offen lds
    s_lshl_b32 s54, s50, 8
    s_add_u32 s52, s54, 7478016
    v_lshlrev_b32 v16, 2, v21
    buffer_load_dwordx4 v[24:27], v16, s[4:7], s52 offen
    s_lshl_b32 s54, s50, 7
    v_lshlrev_b32 v17, 1, v21
    buffer_load_dwordx2 v[28:29], v17, s[8:11], s54 offen
    s_mul_i32 s56, s34, 589824
    s_lshl_b32 s54, s35, 13
    s_add_u32 s56, s56, s54
    s_lshl_b32 s54, s33, 10
    s_add_u32 s56, s56, s54
    s_add_u32 s56, s56, 12582912
    s_waitcnt lgkmcnt(2)
    v_mfma_f32_16x16x32_bf16 v[56:59], v[52:55], v[132:135], v[56:59]
    ds_read_b64_tr_b16 v[48:49], v5 offset:28672
    v_mfma_f32_16x16x32_bf16 v[60:63], v[52:55], v[204:207], v[60:63]
    ds_read_b64_tr_b16 v[50:51], v5 offset:29184
    s_sub_u32 s54, s35, 1
    s_and_b32 s54, s54, 7
    s_mul_i32 s54, s54, 73728
    s_add_u32 s54, s54, s56
    buffer_load_dwordx4 v[76:79], v13, s[4:7], s54 offen sc1
    s_barrier
    s_waitcnt lgkmcnt(2)
    v_mfma_f32_16x16x32_bf16 v[56:59], v[44:47], v[136:139], v[56:59]
    ds_read_b64_tr_b16 v[52:53], v5 offset:32768
    v_mfma_f32_16x16x32_bf16 v[60:63], v[44:47], v[208:211], v[60:63]
    ds_read_b64_tr_b16 v[54:55], v5 offset:33280
    s_sub_u32 s54, s35, 2
    s_and_b32 s54, s54, 7
    s_mul_i32 s54, s54, 73728
    s_add_u32 s54, s54, s56
    buffer_load_dwordx4 v[80:83], v13, s[4:7], s54 offen sc1
    s_waitcnt lgkmcnt(2)
    v_mfma_f32_16x16x32_bf16 v[56:59], v[48:51], v[140:143], v[56:59]
    ds_read_b64_tr_b16 v[44:45], v5 offset:36864
    v_mfma_f32_16x16x32_bf16 v[60:63], v[48:51], v[212:215], v[60:63]
    ds_read_b64_tr_b16 v[46:47], v5 offset:37376
    s_sub_u32 s54, s35, 3
    s_and_b32 s54, s54, 7
    s_mul_i32 s54, s54, 73728
    s_add_u32 s54, s54, s56
    buffer_load_dwordx4 v[84:87], v13, s[4:7], s54 offen sc1
    s_waitcnt lgkmcnt(2)
    v_mfma_f32_16x16x32_bf16 v[56:59], v[52:55], v[144:147], v[56:59]
    ds_read_b64_tr_b16 v[48:49], v5 offset:40960
    v_mfma_f32_16x16x32_bf16 v[60:63], v[52:55], v[216:219], v[60:63]
    ds_read_b64_tr_b16 v[50:51], v5 offset:41472
    s_waitcnt lgkmcnt(2)
    v_mfma_f32_16x16x32_bf16 v[56:59], v[44:47], v[148:151], v[56:59]
    ds_read_b64_tr_b16 v[52:53], v5 offset:45056
    v_mfma_f32_16x16x32_bf16 v[60:63], v[44:47], v[220:223], v[60:63]
    ds_read_b64_tr_b16 v[54:55], v5 offset:45568
    s_sub_u32 s54, s35, 4
    s_and_b32 s54, s54, 7
    s_mul_i32 s54, s54, 73728
    s_add_u32 s54, s54, s56
    buffer_load_dwordx4 v[88:91], v13, s[4:7], s54 offen sc1
    s_waitcnt lgkmcnt(2)
    v_mfma_f32_16x16x32_bf16 v[56:59], v[48:51], v[152:155], v[56:59]
    ds_read_b64_tr_b16 v[44:45], v6 offset:0
    v_mfma_f32_16x16x32_bf16 v[60:63], v[48:51], v[224:227], v[60:63]
    ds_read_b64_tr_b16 v[46:47], v6 offset:512
    s_sub_u32 s54, s35, 5
    s_and_b32 s54, s54, 7
    s_mul_i32 s54, s54, 73728
    s_add_u32 s54, s54, s56
    buffer_load_dwordx4 v[92:95], v13, s[4:7], s54 offen sc1
    s_waitcnt lgkmcnt(2)
    v_mfma_f32_16x16x32_bf16 v[56:59], v[52:55], v[156:159], v[56:59]
    ds_read_b64_tr_b16 v[48:49], v6 offset:4096
    v_mfma_f32_16x16x32_bf16 v[60:63], v[52:55], v[228:231], v[60:63]
    ds_read_b64_tr_b16 v[50:51], v6 offset:4608
    s_waitcnt lgkmcnt(2)
    v_mfma_f32_16x16x32_bf16 v[56:59], v[44:47], v[160:163], v[56:59]
    ds_read_b64_tr_b16 v[52:53], v6 offset:8192
    v_mfma_f32_16x16x32_bf16 v[60:63], v[44:47], v[232:235], v[60:63]
    ds_read_b64_tr_b16 v[54:55], v6 offset:8704
    s_waitcnt lgkmcnt(2)
    v_mfma_f32_16x16x32_bf16 v[56:59], v[48:51], v[164:167], v[56:59]
    ds_read_b64_tr_b16 v[44:45], v6 offset:12288
    v_mfma_f32_16x16x32_bf16 v[60:63], v[48:51], v[236:239], v[60:63]
    ds_read_b64_tr_b16 v[46:47], v6 offset:12800
    s_waitcnt lgkmcnt(2)
    v_mfma_f32_16x16x32_bf16 v[56:59], v[52:55], v[168:171], v[56:59]
    ds_read_b64_tr_b16 v[48:49], v6 offset:16384
    v_mfma_f32_16x16x32_bf16 v[60:63], v[52:55], v[240:243], v[60:63]
    ds_read_b64_tr_b16 v[50:51], v6 offset:16896
    s_waitcnt lgkmcnt(2)
    v_mfma_f32_16x16x32_bf16 v[56:59], v[44:47], v[172:175], v[56:59]
    ds_read_b64_tr_b16 v[52:53], v6 offset:20480
    v_mfma_f32_16x16x32_bf16 v[60:63], v[44:47], v[244:247], v[60:63]
    ds_read_b64_tr_b16 v[54:55], v6 offset:20992
    s_waitcnt lgkmcnt(2)
    v_mfma_f32_16x16x32_bf16 v[56:59], v[48:51], v[176:179], v[56:59]
    v_mfma_f32_16x16x32_bf16 v[60:63], v[48:51], v[248:251], v[60:63]
    s_waitcnt lgkmcnt(0)
    v_mfma_f32_16x16x32_bf16 v[56:59], v[52:55], v[180:183], v[56:59]
    v_mfma_f32_16x16x32_bf16 v[60:63], v[52:55], v[252:255], v[60:63]
    s_cmp_eq_u32 s33, 0
    s_cbranch_scc0 L_nofin8
    v_add_u32 v16, 73728, v13
    ds_read_b128 v[112:115], v16 offset:0
    ds_read_b128 v[116:119], v16 offset:1024
    ds_read_b128 v[120:123], v16 offset:2048
    ds_read_b128 v[124:127], v16 offset:3072
    ds_read_b128 v[128:131], v16 offset:4096
    ds_read_b128 v[132:135], v16 offset:5120
    ds_read_b128 v[136:139], v16 offset:6144
    ds_read_b128 v[140:143], v16 offset:7168
    s_waitcnt lgkmcnt(0)
    s_mov_b32 s50, 8
    s_lshl_b32 s54, 8, 10
    v_add_u32 v16, s54, v20
    ds_read_b64_tr_b16 v[36:37], v16
    ds_read_b64_tr_b16 v[38:39], v16 offset:32
    v_lshlrev_b32 v72, 16, v112
    v_and_b32 v73, 0xffff0000, v112
    v_lshlrev_b32 v74, 16, v113
    v_and_b32 v75, 0xffff0000, v113
    v_lshlrev_b32 v108, 16, v114
    v_and_b32 v109, 0xffff0000, v114
    v_lshlrev_b32 v110, 16, v115
    v_and_b32 v111, 0xffff0000, v115
    v_lshlrev_b32 v22, 16, v116
    v_and_b32 v23, 0xffff0000, v116
    v_add_f32 v72, v72, v22
    v_add_f32 v73, v73, v23
    v_lshlrev_b32 v22, 16, v117
    v_and_b32 v23, 0xffff0000, v117
    v_add_f32 v74, v74, v22
    v_add_f32 v75, v75, v23
    v_lshlrev_b32 v22, 16, v118
    v_and_b32 v23, 0xffff0000, v118
    v_add_f32 v108, v108, v22
    v_add_f32 v109, v109, v23
    v_lshlrev_b32 v22, 16, v119
    v_and_b32 v23, 0xffff0000, v119
    v_add_f32 v110, v110, v22
    v_add_f32 v111, v111, v23
    v_lshlrev_b32 v22, 16, v120
    v_and_b32 v23, 0xffff0000, v120
    v_add_f32 v72, v72, v22
    v_add_f32 v73, v73, v23
    v_lshlrev_b32 v22, 16, v121
    v_and_b32 v23, 0xffff0000, v121
    v_add_f32 v74, v74, v22
    v_add_f32 v75, v75, v23
    v_lshlrev_b32 v22, 16, v122
    v_and_b32 v23, 0xffff0000, v122
    v_add_f32 v108, v108, v22
    v_add_f32 v109, v109, v23
    v_lshlrev_b32 v22, 16, v123
    v_and_b32 v23, 0xffff0000, v123
    v_add_f32 v110, v110, v22
    v_add_f32 v111, v111, v23
    v_lshlrev_b32 v22, 16, v124
    v_and_b32 v23, 0xffff0000, v124
    v_add_f32 v72, v72, v22
    v_add_f32 v73, v73, v23
    v_lshlrev_b32 v22, 16, v125
    v_and_b32 v23, 0xffff0000, v125
    v_add_f32 v74, v74, v22
    v_add_f32 v75, v75, v23
    v_lshlrev_b32 v22, 16, v126
    v_and_b32 v23, 0xffff0000, v126
    v_add_f32 v108, v108, v22
    v_add_f32 v109, v109, v23
    v_lshlrev_b32 v22, 16, v127
    v_and_b32 v23, 0xffff0000, v127
    v_add_f32 v110, v110, v22
    v_add_f32 v111, v111, v23
    v_lshlrev_b32 v22, 16, v128
    v_and_b32 v23, 0xffff0000, v128
    v_add_f32 v72, v72, v22
    v_add_f32 v73, v73, v23
    v_lshlrev_b32 v22, 16, v129
    v_and_b32 v23, 0xffff0000, v129
    v_add_f32 v74, v74, v22
    v_add_f32 v75, v75, v23
    v_lshlrev_b32 v22, 16, v130
    v_and_b32 v23, 0xffff0000, v130
    v_add_f32 v108, v108, v22
    v_add_f32 v109, v109, v23
    v_lshlrev_b32 v22, 16, v131
    v_and_b32 v23, 0xffff0000, v131
    v_add_f32 v110, v110, v22
    v_add_f32 v111, v111, v23
    v_lshlrev_b32 v22, 16, v132
    v_and_b32 v23, 0xffff0000, v132
    v_add_f32 v72, v72, v22
    v_add_f32 v73, v73, v23
    v_lshlrev_b32 v22, 16, v133
    v_and_b32 v23, 0xffff0000, v133
    v_add_f32 v74, v74, v22
    v_add_f32 v75, v75, v23
    v_lshlrev_b32 v22, 16, v134
    v_and_b32 v23, 0xffff0000, v134
    v_add_f32 v108, v108, v22
    v_add_f32 v109, v109, v23
    v_lshlrev_b32 v22, 16, v135
    v_and_b32 v23, 0xffff0000, v135
    v_add_f32 v110, v110, v22
    v_add_f32 v111, v111, v23
    v_lshlrev_b32 v22, 16, v136
    v_and_b32 v23, 0xffff0000, v136
    v_add_f32 v72, v72, v22
    v_add_f32 v73, v73, v23
    v_lshlrev_b32 v22, 16, v137
    v_and_b32 v23, 0xffff0000, v137
    v_add_f32 v74, v74, v22
    v_add_f32 v75, v75, v23
    v_lshlrev_b32 v22, 16, v138
    v_and_b32 v23, 0xffff0000, v138
    v_add_f32 v108, v108, v22
    v_add_f32 v109, v109, v23
    v_lshlrev_b32 v22, 16, v139
    v_and_b32 v23, 0xffff0000, v139
    v_add_f32 v110, v110, v22
    v_add_f32 v111, v111, v23
    v_lshlrev_b32 v22, 16, v140
    v_and_b32 v23, 0xffff0000, v140
    v_add_f32 v72, v72, v22
    v_add_f32 v73, v73, v23
    v_lshlrev_b32 v22, 16, v141
    v_and_b32 v23, 0xffff0000, v141
    v_add_f32 v74, v74, v22
    v_add_f32 v75, v75, v23
    v_lshlrev_b32 v22, 16, v142
    v_and_b32 v23, 0xffff0000, v142
    v_add_f32 v108, v108, v22
    v_add_f32 v109, v109, v23
    v_lshlrev_b32 v22, 16, v143
    v_and_b32 v23, 0xffff0000, v143
    v_add_f32 v110, v110, v22
    v_add_f32 v111, v111, v23
    v_lshlrev_b32 v30, 16, v10
    v_and_b32 v31, 0xffff0000, v10
    v_lshlrev_b32 v32, 16, v11
    v_and_b32 v33, 0xffff0000, v11
    s_waitcnt lgkmcnt(0)
    s_lshl_b32 s54, s50, 7
    v_lshlrev_b32 v16, 16, v36
    v_and_b32 v17, 0xffff0000, v36
    v_lshlrev_b32 v18, 16, v37
    v_and_b32 v4, 0xffff0000, v37
    v_add_f32 v72, v72, v30
    v_fma_f32 v72, v72, v104, v16
    v_add_f32 v73, v73, v31
    v_fma_f32 v73, v73, v105, v17
    v_add_f32 v74, v74, v32
    v_fma_f32 v74, v74, v106, v18
    v_add_f32 v75, v75, v33
    v_fma_f32 v75, v75, v107, v4
    v_cvt_pk_bf16_f32 v34, v72, v73
    v_cvt_pk_bf16_f32 v35, v74, v75
    v_lshlrev_b32 v16, 16, v38
    v_and_b32 v17, 0xffff0000, v38
    v_lshlrev_b32 v18, 16, v39
    v_and_b32 v4, 0xffff0000, v39
    v_add_f32 v108, v108, v30
    v_fma_f32 v108, v108, v104, v16
    v_add_f32 v109, v109, v31
    v_fma_f32 v109, v109, v105, v17
    v_add_f32 v110, v110, v32
    v_fma_f32 v110, v110, v106, v18
    v_add_f32 v111, v111, v33
    v_fma_f32 v111, v111, v107, v4
    v_cvt_pk_bf16_f32 v10, v108, v109
    v_cvt_pk_bf16_f32 v11, v110, v111
    buffer_store_dwordx2 v[34:35], v3, s[28:31], s54 offen
    s_add_u32 s54, s54, 18432
    buffer_store_dwordx2 v[10:11], v3, s[28:31], s54 offen
    s_mov_b32 s50, s35
L_nofin8:
    s_waitcnt vmcnt(0)
    s_mov_b32 s51, 0x40000
    s_sub_u32 s54, s35, 6
    s_and_b32 s54, s54, 7
    s_mul_i32 s54, s54, 73728
    s_add_u32 s54, s54, s56
    buffer_load_dwordx4 v[96:99], v13, s[4:7], s54 offen sc1
    s_sub_u32 s54, s35, 7
    s_and_b32 s54, s54, 7
    s_mul_i32 s54, s54, 73728
    s_add_u32 s54, s54, s56
    buffer_load_dwordx4 v[100:103], v13, s[4:7], s54 offen sc1
    v_lshlrev_b32 v22, 16, v76
    v_and_b32 v23, 0xffff0000, v76
    v_add_f32 v56, v56, v22
    v_add_f32 v57, v57, v23
    v_lshlrev_b32 v22, 16, v77
    v_and_b32 v23, 0xffff0000, v77
    v_add_f32 v58, v58, v22
    v_add_f32 v59, v59, v23
    v_lshlrev_b32 v22, 16, v78
    v_and_b32 v23, 0xffff0000, v78
    v_add_f32 v60, v60, v22
    v_add_f32 v61, v61, v23
    v_lshlrev_b32 v22, 16, v79
    v_and_b32 v23, 0xffff0000, v79
    v_add_f32 v62, v62, v22
    v_add_f32 v63, v63, v23
    v_lshlrev_b32 v22, 16, v80
    v_and_b32 v23, 0xffff0000, v80
    v_add_f32 v56, v56, v22
    v_add_f32 v57, v57, v23
    v_lshlrev_b32 v22, 16, v81
    v_and_b32 v23, 0xffff0000, v81
    v_add_f32 v58, v58, v22
    v_add_f32 v59, v59, v23
    v_lshlrev_b32 v22, 16, v82
    v_and_b32 v23, 0xffff0000, v82
    v_add_f32 v60, v60, v22
    v_add_f32 v61, v61, v23
    v_lshlrev_b32 v22, 16, v83
    v_and_b32 v23, 0xffff0000, v83
    v_add_f32 v62, v62, v22
    v_add_f32 v63, v63, v23
    v_lshlrev_b32 v22, 16, v84
    v_and_b32 v23, 0xffff0000, v84
    v_add_f32 v56, v56, v22
    v_add_f32 v57, v57, v23
    v_lshlrev_b32 v22, 16, v85
    v_and_b32 v23, 0xffff0000, v85
    v_add_f32 v58, v58, v22
    v_add_f32 v59, v59, v23
    v_lshlrev_b32 v22, 16, v86
    v_and_b32 v23, 0xffff0000, v86
    v_add_f32 v60, v60, v22
    v_add_f32 v61, v61, v23
    v_lshlrev_b32 v22, 16, v87
    v_and_b32 v23, 0xffff0000, v87
    v_add_f32 v62, v62, v22
    v_add_f32 v63, v63, v23
    v_lshlrev_b32 v22, 16, v88
    v_and_b32 v23, 0xffff0000, v88
    v_add_f32 v56, v56, v22
    v_add_f32 v57, v57, v23
    v_lshlrev_b32 v22, 16, v89
    v_and_b32 v23, 0xffff0000, v89
    v_add_f32 v58, v58, v22
    v_add_f32 v59, v59, v23
    v_lshlrev_b32 v22, 16, v90
    v_and_b32 v23, 0xffff0000, v90
    v_add_f32 v60, v60, v22
    v_add_f32 v61, v61, v23
    v_lshlrev_b32 v22, 16, v91
    v_and_b32 v23, 0xffff0000, v91
    v_add_f32 v62, v62, v22
    v_add_f32 v63, v63, v23
    v_lshlrev_b32 v22, 16, v92
    v_and_b32 v23, 0xffff0000, v92
    v_add_f32 v56, v56, v22
    v_add_f32 v57, v57, v23
    v_lshlrev_b32 v22, 16, v93
    v_and_b32 v23, 0xffff0000, v93
    v_add_f32 v58, v58, v22
    v_add_f32 v59, v59, v23
    v_lshlrev_b32 v22, 16, v94
    v_and_b32 v23, 0xffff0000, v94
    v_add_f32 v60, v60, v22
    v_add_f32 v61, v61, v23
    v_lshlrev_b32 v22, 16, v95
    v_and_b32 v23, 0xffff0000, v95
    v_add_f32 v62, v62, v22
    v_add_f32 v63, v63, v23
L_retry:
    s_waitcnt vmcnt(0)
    v_max3_u32 v22, v96, v97, v98
    v_max3_u32 v22, v22, v99, v100
    v_max3_u32 v22, v22, v101, v102
    v_max_u32 v22, v22, v103
    v_cmp_eq_u32 vcc, -1, v22
    s_sub_u32 s51, s51, 1
    s_cmp_eq_u32 s51, 0
    s_cbranch_scc1 L_got
    s_nop 1
    s_cbranch_vccz L_got
    s_sub_u32 s54, s35, 6
    s_and_b32 s54, s54, 7
    s_mul_i32 s54, s54, 73728
    s_add_u32 s54, s54, s56
    buffer_load_dwordx4 v[96:99], v13, s[4:7], s54 offen sc1
    s_sub_u32 s54, s35, 7
    s_and_b32 s54, s54, 7
    s_mul_i32 s54, s54, 73728
    s_add_u32 s54, s54, s56
    buffer_load_dwordx4 v[100:103], v13, s[4:7], s54 offen sc1
    s_branch L_retry
L_got:
    s_lshl_b32 s54, s33, 10
    v_add_u32 v16, s54, v20
    ds_read_b64_tr_b16 v[36:37], v16
    ds_read_b64_tr_b16 v[38:39], v16 offset:32
    v_lshlrev_b32 v22, 16, v96
    v_and_b32 v23, 0xffff0000, v96
    v_add_f32 v56, v56, v22
    v_add_f32 v57, v57, v23
    v_lshlrev_b32 v22, 16, v97
    v_and_b32 v23, 0xffff0000, v97
    v_add_f32 v58, v58, v22
    v_add_f32 v59, v59, v23
    v_lshlrev_b32 v22, 16, v98
    v_and_b32 v23, 0xffff0000, v98
    v_add_f32 v60, v60, v22
    v_add_f32 v61, v61, v23
    v_lshlrev_b32 v22, 16, v99
    v_and_b32 v23, 0xffff0000, v99
    v_add_f32 v62, v62, v22
    v_add_f32 v63, v63, v23
    v_lshlrev_b32 v22, 16, v100
    v_and_b32 v23, 0xffff0000, v100
    v_add_f32 v56, v56, v22
    v_add_f32 v57, v57, v23
    v_lshlrev_b32 v22, 16, v101
    v_and_b32 v23, 0xffff0000, v101
    v_add_f32 v58, v58, v22
    v_add_f32 v59, v59, v23
    v_lshlrev_b32 v22, 16, v102
    v_and_b32 v23, 0xffff0000, v102
    v_add_f32 v60, v60, v22
    v_add_f32 v61, v61, v23
    v_lshlrev_b32 v22, 16, v103
    v_and_b32 v23, 0xffff0000, v103
    v_add_f32 v62, v62, v22
    v_add_f32 v63, v63, v23
    v_lshlrev_b32 v30, 16, v28
    v_and_b32 v31, 0xffff0000, v28
    v_lshlrev_b32 v32, 16, v29
    v_and_b32 v33, 0xffff0000, v29
    s_waitcnt lgkmcnt(0)
    s_lshl_b32 s54, s50, 7
    v_lshlrev_b32 v16, 16, v36
    v_and_b32 v17, 0xffff0000, v36
    v_lshlrev_b32 v18, 16, v37
    v_and_b32 v4, 0xffff0000, v37
    v_add_f32 v56, v56, v30
    v_fma_f32 v56, v56, v24, v16
    v_add_f32 v57, v57, v31
    v_fma_f32 v57, v57, v25, v17
    v_add_f32 v58, v58, v32
    v_fma_f32 v58, v58, v26, v18
    v_add_f32 v59, v59, v33
    v_fma_f32 v59, v59, v27, v4
    v_cvt_pk_bf16_f32 v34, v56, v57
    v_cvt_pk_bf16_f32 v35, v58, v59
    v_lshlrev_b32 v16, 16, v38
    v_and_b32 v17, 0xffff0000, v38
    v_lshlrev_b32 v18, 16, v39
    v_and_b32 v4, 0xffff0000, v39
    v_add_f32 v60, v60, v30
    v_fma_f32 v60, v60, v24, v16
    v_add_f32 v61, v61, v31
    v_fma_f32 v61, v61, v25, v17
    v_add_f32 v62, v62, v32
    v_fma_f32 v62, v62, v26, v18
    v_add_f32 v63, v63, v33
    v_fma_f32 v63, v63, v27, v4
    v_cvt_pk_bf16_f32 v10, v60, v61
    v_cvt_pk_bf16_f32 v11, v62, v63
    buffer_store_dwordx2 v[34:35], v8, s[28:31], s54 offen
    s_add_u32 s54, s54, 18432
    buffer_store_dwordx2 v[10:11], v8, s[28:31], s54 offen
    s_waitcnt vmcnt(0)
L_mlp_end:
    s_endpgm
.section .rodata,"a"
.p2align 6
L_kd_mlp_kernel:
.amdhsa_kernel mlp_kernel
  .amdhsa_next_free_vgpr 256
  .amdhsa_next_free_sgpr 96
  .amdhsa_accum_offset 256
  .amdhsa_group_segment_fixed_size 0
  .amdhsa_kernarg_size 136
  .amdhsa_user_sgpr_count 2
  .amdhsa_user_sgpr_kernarg_segment_ptr 1
  .amdhsa_system_sgpr_workgroup_id_x 1
  .amdhsa_float_denorm_mode_32 3
.end_amdhsa_kernel
```
